```python
import torch

def _softmax(x, axis=-1):
    return torch.softmax(x, dim=axis)
def _gelu(x):
    return torch.nn.functional.gelu(x, approximate="tanh")
def _silu(x):
    return torch.nn.functional.silu(x)
def _sigmoid(x):
    return torch.sigmoid(x)
def _layernorm(x, axis=-1, eps=1e-5):
    m = x.mean(dim=axis, keepdim=True)
    v = x.var(dim=axis, keepdim=True, unbiased=False)
    return (x - m) / torch.sqrt(v + eps)
def _scatter_add(tgt, idx, src, axis=0):
    return tgt.clone().index_add_(axis, idx, src)
def _segment_sum(src, seg, n):
    out = torch.zeros((n,) + src.shape[1:], dtype=src.dtype)
    return out.index_add_(0, seg, src)
def _pad(x, pw):
    flat = tuple(v for pair in reversed(pw) for v in pair)
    return torch.nn.functional.pad(x, flat)

kernel_name = 'parallel_sum__spectral_gfnet__glu_gated_swiglu__prompt'

def setup_inputs():

    _w = (lambda a: (lambda t: t.to(torch.bfloat16) if t.is_floating_point() else t)(torch.as_tensor(a)))
    def _A_setup():
        B, S, D = 1, 2048, 448
        Df = D // 2 + 1
        return {
            "x": _w((lambda *s: torch.randn(*s, dtype=torch.bfloat16) * 0.05)(B, S, D)),
            "w_r": _w((lambda *s: torch.randn(*s, dtype=torch.bfloat16) * 0.4)(S, Df) * 0.02),
            "w_i": _w((lambda *s: torch.randn(*s, dtype=torch.bfloat16) * 0.4)(S, Df) * 0.02),
        }
    _A_in = _A_setup()

    def _B_setup():
        B, S, D, F = 1, 2048, 448, 1792
        return {
            "x": _w((lambda *s: torch.randn(*s, dtype=torch.bfloat16) * 0.05)(B, S, D)),
            "w1": _w((lambda *s: torch.randn(*s, dtype=torch.bfloat16) * 0.2)(D, F) * (2.0 / D) ** 0.5),
            "w3": _w((lambda *s: torch.randn(*s, dtype=torch.bfloat16) * 0.2)(D, F) * (2.0 / D) ** 0.5),
            "w2": _w((lambda *s: torch.randn(*s, dtype=torch.bfloat16) * 0.2)(F, D) * (2.0 / F) ** 0.5),
        }
    _B_in = _B_setup()

    return {
        "A_x": _A_in["x"],
        "A_w_r": _A_in["w_r"],
        "A_w_i": _A_in["w_i"],
        "B_x": _B_in["x"],
        "B_w1": _B_in["w1"],
        "B_w3": _B_in["w3"],
        "B_w2": _B_in["w2"],
    }

def reference(A_x, A_w_r, A_w_i, B_x, B_w1, B_w3, B_w2):
    def _A_ref(x, w_r, w_i):
        B, S, D = x.shape
        X = (lambda x, axes=(-2,-1): torch.fft.rfft2(x.float(), dim=axes))(x, axes=(-2, -1))
        W = w_r + 1j * w_i
        X = X * W
        y = (lambda x, s, axes=(-2,-1): torch.fft.irfft2(x, s=s, dim=axes).to(torch.bfloat16))(X, (S, D), axes=(-2, -1))
        return y

    def _B_ref(x, w1, w3, w2):
        gate = torch.einsum("bsd,df->bsf", x, w1)
        up = torch.einsum("bsd,df->bsf", x, w3)
        h = _silu(gate) * up
        out = torch.einsum("bsf,fd->bsd", h, w2)
        return out

    x = A_x
    xn = _layernorm(x, axis=-1)
    return x + _A_ref(xn, A_w_r, A_w_i) + _B_ref(xn, B_w1, B_w3, B_w2)
```

```asm
; @launch grid=(256,1,1) block=(256,1,1) lds=163840
.amdgcn_target "amdgcn-amd-amdhsa--gfx950"
.text
.globl parallel_sum__spectral_gfnet__glu_gated_swiglu__prompt_kernel
.p2align 12
.p2align 8
.type parallel_sum__spectral_gfnet__glu_gated_swiglu__prompt_kernel,@function
parallel_sum__spectral_gfnet__glu_gated_swiglu__prompt_kernel:
    s_load_dwordx16 s[4:19], s[0:1], 0
    s_load_dwordx4 s[20:23], s[0:1], 64
    v_lshrrev_b32 v1, 6, v0
    v_and_b32 v0, 63, v0
    v_readfirstlane_b32 s44, v1
    s_lshr_b32 s50, s2, 3
    s_and_b32 s51, s2, 7
    s_cmp_ge_u32 s2, 256
    s_cbranch_scc1 L_end
    s_lshl2_add_u32 s63, s50, s44
    s_min_u32 s52, s63, (L_codeend-L_pc)/1024
    s_lshl_b32 s52, s52, 10
    s_getpc_b64 s[54:55]
L_pc:
    v_lshlrev_b32 v1, 4, v0
    v_add_u32 v2, s52, v1
    global_load_dwordx4 a[252:255], v2, s[54:55]
    s_cmp_ge_u32 s50, 28
    s_cbranch_scc1 L_fft
    s_and_b32 s52, s51, 1
    s_lshl1_add_u32 s63, s63, s52
    s_lshl_b32 s63, s63, 4
    s_lshr_b32 s62, s51, 1
    s_mul_i32 s62, s62, 14336
    s_mov_b32 s57, 38347923
    s_mov_b32 s26, 1835008
    s_mov_b32 s27, 0x20000
    v_min_u32 v248, 15, v0
    v_add_u32 v248, s63, v248
    v_mul_hi_u32 v249, v248, s57
    v_mul_u32_u24 v249, 336, v249
    v_add_lshl_u32 v248, v248, v249, 7
    s_waitcnt lgkmcnt(0)
    s_mov_b64 s[24:25], s[4:5]
    buffer_load_dword a176, v248, s[24:27], s62 offen
    s_load_dword s49, s[22:23], 0
    s_mul_i32 s52, s50, 37
    s_lshr_b32 s52, s52, 8
    s_mul_i32 s53, s52, 7
    s_sub_u32 s48, s50, s53
    s_lshr_b32 s53, s51, 1
    s_lshl2_add_u32 s45, s53, s52
    s_and_b32 s53, s51, 1
    s_mul_i32 s53, s53, 7
    s_add_u32 s46, s53, s48
    s_lshl2_add_u32 s47, s51, s52
    s_mul_i32 s60, s44, 28672
    s_lshl2_add_u32 s53, s45, s44
    s_mul_i32 s54, s53, 896
    s_lshl4_add_u32 s55, s46, 1
    s_lshl_b32 s56, s44, 6
    s_lshl_b32 s62, s44, 12
    s_add_u32 s62, s62, 114688
    s_mov_b32 s64, 0x3f803f80
    v_and_b32 v2, 31, v0
    v_lshrrev_b32 v3, 5, v0
    v_lshrrev_b32 v200, 3, v0
    v_and_b32 v201, 7, v0
    v_lshrrev_b32 v202, 1, v200
    v_xor_b32 v202, v202, v201
    v_lshlrev_b32 v202, 4, v202
    v_mul_u32_u24 v9, 57344, v200
    v_add3_u32 v8, v9, v202, s54
    v_xor_b32 v9, 64, v8
    v_add_u32 v10, 915456, v8
    v_add_u32 v11, 1373184, v9
    v_add_u32 v9, 457728, v9
    v_mov_b32 v207, 0x3b124925
    v_add_u32 v203, s62, v1
    s_add_u32 m0, s60, 0
    s_movk_i32 s62, 0
    buffer_load_dwordx4 v8, s[24:27], s62 offen offset:0 lds
    s_mov_b64 s[36:37], s[22:23]
    s_mov_b32 s38, 13893632
    s_mov_b32 s39, 0x20000
    s_lshl2_add_u32 s63, s2, s44
    s_mul_i32 s58, s63, 1152
    s_mul_i32 s67, s63, 1792
    s_lshl_b32 s63, s63, 7
    s_add_u32 s63, s63, 4096
    s_and_b32 s66, s44, 1
    s_lshl1_add_u32 s66, s2, s66
    s_mul_i32 s66, s66, 3584
    s_mov_b64 s[40:41], s[8:9]
    s_mov_b32 s42, 921600
    s_mov_b32 s43, 0x20000
    s_mov_b64 s[32:33], s[16:17]
    s_mov_b32 s34, 1605632
    s_mov_b32 s35, 0x20000
    s_cmp_ge_u32 s44, 2
    s_cselect_b64 s[28:29], s[14:15], s[12:13]
    s_mov_b32 s30, 1605632
    s_mov_b32 s31, 0x20000
    v_min_u32 v253, 13, v0
    v_lshlrev_b32 v252, 8, v253
    v_lshlrev_b32 v253, 7, v253
    v_min_u32 v249, 1024, v253
    v_mov_b32 v23, 0
    v_min_u32 v20, 1, v0
    v_lshlrev_b32 v20, 30, v20
    buffer_load_dwordx4 v9, s[24:27], s62 offen offset:1024 lds
    buffer_load_dword a177, v249, s[40:43], s58 offen
    buffer_atomic_or v23, v20, s[36:39], s63 offen sc1
    v_lshrrev_b32 v204, 1, v2
    v_add_u32 v204, s55, v204
    v_lshl_add_u32 v205, v3, 3, s56
    v_mul_u32_u24 v205, v205, v204
    v_and_b32 v216, 1, v0
    v_mul_u32_u24 v216, 112, v216
    v_add_u32 v205, v205, v216
    v_lshlrev_b32 v218, 31, v204
    buffer_load_dwordx4 v10, s[24:27], s62 offen offset:2048 lds
    v_or_b32 v218, 1.0, v218
    v_cvt_f32_u32 v204, v204
    v_cvt_f32_u32 v205, v205
    v_mul_f32 v206, 0x41800000, v204
    v_fmaak_f32 v216, v205, v207, 0x3a924925
    v_floor_f32 v216, v216
    v_fmamk_f32 v205, v216, 0xc3e00000, v205
    v_mul_f32 v205, v205, v207
    v_fmaak_f32 v216, v206, v207, 0x3a924925
    v_floor_f32 v216, v216
    v_fmamk_f32 v206, v216, 0xc3e00000, v206
    v_mul_f32 v206, v206, v207
    v_mul_f32 v204, v204, v207
    v_fmamk_f32 v221, v204, 0x3f800000, v205
    v_fmamk_f32 v222, v204, 0x40000000, v205
    v_fmamk_f32 v223, v204, 0x40400000, v205
    buffer_load_dwordx4 v11, s[24:27], s62 offen offset:3072 lds
    v_fmamk_f32 v224, v204, 0x40800000, v205
    v_fmamk_f32 v225, v204, 0x40a00000, v205
    v_fmamk_f32 v226, v204, 0x40c00000, v205
    v_fmamk_f32 v227, v204, 0x40e00000, v205
    v_cos_f32 v220, v205
    v_cos_f32 v221, v221
    v_cos_f32 v222, v222
    v_cos_f32 v223, v223
    v_cos_f32 v224, v224
    v_cos_f32 v225, v225
    v_cos_f32 v226, v226
    v_cos_f32 v227, v227
    v_cvt_pk_bf16_f32 v228, v220, v221
    v_cvt_pk_bf16_f32 v229, v222, v223
    v_cvt_pk_bf16_f32 v230, v224, v225
    s_add_u32 m0, s60, 4096
    s_movk_i32 s62, 128
    buffer_load_dwordx4 v8, s[24:27], s62 offen offset:0 lds
    v_cvt_pk_bf16_f32 v231, v226, v227
    v_add_f32 v205, v205, v206
    v_fmamk_f32 v221, v204, 0x3f800000, v205
    v_fmamk_f32 v222, v204, 0x40000000, v205
    v_fmamk_f32 v223, v204, 0x40400000, v205
    v_fmamk_f32 v224, v204, 0x40800000, v205
    v_fmamk_f32 v225, v204, 0x40a00000, v205
    v_fmamk_f32 v226, v204, 0x40c00000, v205
    v_fmamk_f32 v227, v204, 0x40e00000, v205
    v_cos_f32 v220, v205
    v_cos_f32 v221, v221
    v_cos_f32 v222, v222
    v_cos_f32 v223, v223
    v_cos_f32 v224, v224
    v_cos_f32 v225, v225
    buffer_load_dwordx4 v9, s[24:27], s62 offen offset:1024 lds
    v_cos_f32 v226, v226
    v_cos_f32 v227, v227
    v_cvt_pk_bf16_f32 v232, v220, v221
    v_cvt_pk_bf16_f32 v233, v222, v223
    v_cvt_pk_bf16_f32 v234, v224, v225
    v_cvt_pk_bf16_f32 v235, v226, v227
    v_add_f32 v205, v205, v206
    v_fmamk_f32 v221, v204, 0x3f800000, v205
    v_fmamk_f32 v222, v204, 0x40000000, v205
    v_fmamk_f32 v223, v204, 0x40400000, v205
    v_fmamk_f32 v224, v204, 0x40800000, v205
    v_fmamk_f32 v225, v204, 0x40a00000, v205
    v_fmamk_f32 v226, v204, 0x40c00000, v205
    v_fmamk_f32 v227, v204, 0x40e00000, v205
    v_cos_f32 v220, v205
    v_cos_f32 v221, v221
    buffer_load_dwordx4 v10, s[24:27], s62 offen offset:2048 lds
    v_cos_f32 v222, v222
    v_cos_f32 v223, v223
    v_cos_f32 v224, v224
    v_cos_f32 v225, v225
    v_cos_f32 v226, v226
    v_cos_f32 v227, v227
    v_cvt_pk_bf16_f32 v236, v220, v221
    v_cvt_pk_bf16_f32 v237, v222, v223
    v_cvt_pk_bf16_f32 v238, v224, v225
    v_cvt_pk_bf16_f32 v239, v226, v227
    v_add_f32 v205, v205, v206
    v_fmamk_f32 v221, v204, 0x3f800000, v205
    v_fmamk_f32 v222, v204, 0x40000000, v205
    v_fmamk_f32 v223, v204, 0x40400000, v205
    v_fmamk_f32 v224, v204, 0x40800000, v205
    buffer_load_dwordx4 v11, s[24:27], s62 offen offset:3072 lds
    v_fmamk_f32 v225, v204, 0x40a00000, v205
    v_fmamk_f32 v226, v204, 0x40c00000, v205
    v_fmamk_f32 v227, v204, 0x40e00000, v205
    v_cos_f32 v220, v205
    v_cos_f32 v221, v221
    v_cos_f32 v222, v222
    v_cos_f32 v223, v223
    v_cos_f32 v224, v224
    v_cos_f32 v225, v225
    v_cos_f32 v226, v226
    v_cos_f32 v227, v227
    v_cvt_pk_bf16_f32 v240, v220, v221
    v_cvt_pk_bf16_f32 v241, v222, v223
    v_cvt_pk_bf16_f32 v242, v224, v225
    v_cvt_pk_bf16_f32 v243, v226, v227
    ds_write_b128 v203, v[228:231] offset:0
    ds_write_b128 v203, v[232:235] offset:1024
    s_mov_b32 s72, 0
    s_mov_b32 s73, 229376
    s_mov_b32 s74, 458752
    s_mov_b32 s75, 688128
    s_add_u32 m0, s60, 8192
    s_movk_i32 s62, 256
    buffer_load_dwordx4 v8, s[24:27], s62 offen offset:0 lds
    ds_write_b128 v203, v[236:239] offset:2048
    ds_write_b128 v203, v[240:243] offset:3072
    s_mov_b32 s76, 917504
    s_mov_b32 s77, 1146880
    s_mov_b32 s78, 1376256
    v_bfe_u32 v244, v2, 1, 3
    v_xor_b32 v244, v244, v3
    v_lshlrev_b32 v244, 4, v244
    v_lshl_add_u32 v244, v2, 7, v244
    v_add_u32 v244, s60, v244
    v_xor_b32 v245, 32, v244
    v_xor_b32 v246, 64, v244
    v_xor_b32 v247, 96, v244
    v_mov_b32 v208, 0
    v_mov_b32 v210, 0
    v_add_u32 v204, 114688, v1
    s_waitcnt lgkmcnt(0)
    s_barrier
    s_mov_b64 exec, 0
    s_cmp_eq_u32 s44, 0
    s_cbranch_scc1 L_padg0
    s_cmp_eq_u32 s44, 1
    s_cbranch_scc1 L_padg1
    s_cmp_eq_u32 s44, 2
    s_cbranch_scc1 L_padg2
    s_branch L_padg3
L_backg:
    s_mov_b64 exec, -1
L_warmg:
    s_waitcnt vmcnt(5)
    ds_read_b128 v[24:27], v244 offset:0
    ds_read_b128 v[28:31], v245 offset:0
    ds_read_b128 v[32:35], v246 offset:0
    ds_read_b128 v[36:39], v247 offset:0
    ds_read_b128 a[0:3], v204 offset:0
    ds_read_b128 a[4:7], v204 offset:1024
    ds_read_b128 a[8:11], v204 offset:2048
    ds_read_b128 a[12:15], v204 offset:3072
    buffer_load_dwordx4 v9, s[24:27], s62 offen offset:1024 lds
    buffer_load_dwordx4 v10, s[24:27], s62 offen offset:2048 lds
    buffer_load_dwordx4 v11, s[24:27], s62 offen offset:3072 lds
    s_waitcnt lgkmcnt(4)
    s_add_u32 m0, s60, 12288
    s_movk_i32 s62, 384
    v_dot2_f32_bf16 v208, v24, s64, v208
    v_dot2_f32_bf16 v210, v24, v24, v210
    v_dot2_f32_bf16 v208, v25, s64, v208
    v_dot2_f32_bf16 v210, v25, v25, v210
    v_dot2_f32_bf16 v208, v26, s64, v208
    v_dot2_f32_bf16 v210, v26, v26, v210
    v_dot2_f32_bf16 v208, v27, s64, v208
    v_dot2_f32_bf16 v210, v27, v27, v210
    v_dot2_f32_bf16 v208, v28, s64, v208
    v_dot2_f32_bf16 v210, v28, v28, v210
    v_dot2_f32_bf16 v208, v29, s64, v208
    v_dot2_f32_bf16 v210, v29, v29, v210
    v_dot2_f32_bf16 v208, v30, s64, v208
    v_dot2_f32_bf16 v210, v30, v30, v210
    v_dot2_f32_bf16 v208, v31, s64, v208
    v_dot2_f32_bf16 v210, v31, v31, v210
    buffer_load_dwordx4 v8, s[24:27], s62 offen offset:0 lds
    v_dot2_f32_bf16 v208, v32, s64, v208
    v_dot2_f32_bf16 v210, v32, v32, v210
    v_dot2_f32_bf16 v208, v33, s64, v208
    v_dot2_f32_bf16 v210, v33, v33, v210
    v_dot2_f32_bf16 v208, v34, s64, v208
    v_dot2_f32_bf16 v210, v34, v34, v210
    v_dot2_f32_bf16 v208, v35, s64, v208
    v_dot2_f32_bf16 v210, v35, v35, v210
    v_dot2_f32_bf16 v208, v36, s64, v208
    v_dot2_f32_bf16 v210, v36, v36, v210
    v_dot2_f32_bf16 v208, v37, s64, v208
    v_dot2_f32_bf16 v210, v37, v37, v210
    v_dot2_f32_bf16 v208, v38, s64, v208
    v_dot2_f32_bf16 v210, v38, v38, v210
    v_dot2_f32_bf16 v208, v39, s64, v208
    v_dot2_f32_bf16 v210, v39, v39, v210
    s_waitcnt lgkmcnt(3)
    v_mfma_f32_32x32x16_bf16 v[136:151], v[24:27], a[0:3], 0
    buffer_load_dwordx4 v9, s[24:27], s62 offen offset:1024 lds
    s_waitcnt vmcnt(6)
    ds_read_b128 v[40:43], v244 offset:4096
    ds_read_b128 v[44:47], v245 offset:4096
    ds_read_b128 v[48:51], v246 offset:4096
    ds_read_b128 v[52:55], v247 offset:4096
    s_waitcnt lgkmcnt(6)
    v_mfma_f32_32x32x16_bf16 v[136:151], v[28:31], a[4:7], v[136:151]
    ds_read_b128 a[16:19], v204 offset:4096
    ds_read_b128 a[20:23], v204 offset:5120
    ds_read_b128 a[24:27], v204 offset:6144
    ds_read_b128 a[28:31], v204 offset:7168
    s_and_b32 s55, s44, 1
    s_mul_i32 s55, s55, 28672
    s_waitcnt lgkmcnt(9)
    v_mfma_f32_32x32x16_bf16 v[136:151], v[32:35], a[8:11], v[136:151]
    buffer_load_dwordx4 v10, s[24:27], s62 offen offset:2048 lds
    s_lshl_b32 s56, s46, 8
    s_add_u32 s55, s55, s56
    s_lshl_b32 s54, s44, 10
    s_add_u32 s54, s54, 147456
    s_waitcnt lgkmcnt(8)
    v_mfma_f32_32x32x16_bf16 v[136:151], v[36:39], a[12:15], v[136:151]
    s_waitcnt lgkmcnt(0)
    s_lshl_b32 s56, s44, 7
    s_add_u32 s56, s56, 155648
    s_lshl2_add_u32 s57, s46, s44
    v_lshlrev_b32 v202, 1, v200
    v_and_b32 v202, 4, v202
    buffer_load_dwordx4 v11, s[24:27], s62 offen offset:3072 lds
    s_add_u32 m0, s60, 16384
    s_movk_i32 s62, 512
    v_dot2_f32_bf16 v208, v40, s64, v208
    v_dot2_f32_bf16 v210, v40, v40, v210
    v_dot2_f32_bf16 v208, v41, s64, v208
    v_dot2_f32_bf16 v210, v41, v41, v210
    v_dot2_f32_bf16 v208, v42, s64, v208
    v_dot2_f32_bf16 v210, v42, v42, v210
    v_dot2_f32_bf16 v208, v43, s64, v208
    v_dot2_f32_bf16 v210, v43, v43, v210
    v_dot2_f32_bf16 v208, v44, s64, v208
    v_dot2_f32_bf16 v210, v44, v44, v210
    v_dot2_f32_bf16 v208, v45, s64, v208
    v_dot2_f32_bf16 v210, v45, v45, v210
    v_dot2_f32_bf16 v208, v46, s64, v208
    v_dot2_f32_bf16 v210, v46, v46, v210
    v_dot2_f32_bf16 v208, v47, s64, v208
    v_dot2_f32_bf16 v210, v47, v47, v210
    buffer_load_dwordx4 v8, s[24:27], s62 offen offset:0 lds
    v_dot2_f32_bf16 v208, v48, s64, v208
    v_dot2_f32_bf16 v210, v48, v48, v210
    v_dot2_f32_bf16 v208, v49, s64, v208
    v_dot2_f32_bf16 v210, v49, v49, v210
    v_dot2_f32_bf16 v208, v50, s64, v208
    v_dot2_f32_bf16 v210, v50, v50, v210
    v_dot2_f32_bf16 v208, v51, s64, v208
    v_dot2_f32_bf16 v210, v51, v51, v210
    v_dot2_f32_bf16 v208, v52, s64, v208
    v_dot2_f32_bf16 v210, v52, v52, v210
    v_dot2_f32_bf16 v208, v53, s64, v208
    v_dot2_f32_bf16 v210, v53, v53, v210
    v_dot2_f32_bf16 v208, v54, s64, v208
    v_dot2_f32_bf16 v210, v54, v54, v210
    v_dot2_f32_bf16 v208, v55, s64, v208
    v_dot2_f32_bf16 v210, v55, v55, v210
    v_mfma_f32_32x32x16_bf16 v[136:151], v[40:43], a[16:19], v[136:151]
    buffer_load_dwordx4 v9, s[24:27], s62 offen offset:1024 lds
    s_waitcnt vmcnt(6)
    ds_read_b128 v[56:59], v244 offset:8192
    ds_read_b128 v[60:63], v245 offset:8192
    ds_read_b128 v[64:67], v246 offset:8192
    ds_read_b128 v[68:71], v247 offset:8192
    v_mfma_f32_32x32x16_bf16 v[136:151], v[44:47], a[20:23], v[136:151]
    ds_read_b128 a[32:35], v204 offset:8192
    ds_read_b128 a[36:39], v204 offset:9216
    ds_read_b128 a[40:43], v204 offset:10240
    ds_read_b128 a[44:47], v204 offset:11264
    v_xor_b32 v202, v202, v201
    v_lshlrev_b32 v202, 4, v202
    v_mfma_f32_32x32x16_bf16 v[136:151], v[48:51], a[24:27], v[136:151]
    buffer_load_dwordx4 v10, s[24:27], s62 offen offset:2048 lds
    v_mul_u32_u24 v4, 3584, v200
    v_add3_u32 v4, v4, v202, s55
    v_add_u32 v5, 56320, v4
    v_add_u32 v6, 112640, v4
    v_mfma_f32_32x32x16_bf16 v[136:151], v[52:55], a[28:31], v[136:151]
    s_waitcnt lgkmcnt(0)
    s_and_b32 s55, s45, 8
    s_mul_i32 s55, s55, 3
    s_add_u32 s55, s55, s45
    s_lshl_b32 s52, s57, 9
    s_add_u32 s52, s52, s55
    buffer_load_dwordx4 v11, s[24:27], s62 offen offset:3072 lds
    s_add_u32 m0, s60, 20480
    s_movk_i32 s62, 640
    v_dot2_f32_bf16 v208, v56, s64, v208
    v_dot2_f32_bf16 v210, v56, v56, v210
    v_dot2_f32_bf16 v208, v57, s64, v208
    v_dot2_f32_bf16 v210, v57, v57, v210
    v_dot2_f32_bf16 v208, v58, s64, v208
    v_dot2_f32_bf16 v210, v58, v58, v210
    v_dot2_f32_bf16 v208, v59, s64, v208
    v_dot2_f32_bf16 v210, v59, v59, v210
    v_dot2_f32_bf16 v208, v60, s64, v208
    v_dot2_f32_bf16 v210, v60, v60, v210
    v_dot2_f32_bf16 v208, v61, s64, v208
    v_dot2_f32_bf16 v210, v61, v61, v210
    v_dot2_f32_bf16 v208, v62, s64, v208
    v_dot2_f32_bf16 v210, v62, v62, v210
    v_dot2_f32_bf16 v208, v63, s64, v208
    v_dot2_f32_bf16 v210, v63, v63, v210
    buffer_load_dwordx4 v8, s[24:27], s62 offen offset:0 lds
    v_dot2_f32_bf16 v208, v64, s64, v208
    v_dot2_f32_bf16 v210, v64, v64, v210
    v_dot2_f32_bf16 v208, v65, s64, v208
    v_dot2_f32_bf16 v210, v65, v65, v210
    v_dot2_f32_bf16 v208, v66, s64, v208
    v_dot2_f32_bf16 v210, v66, v66, v210
    v_dot2_f32_bf16 v208, v67, s64, v208
    v_dot2_f32_bf16 v210, v67, v67, v210
    v_dot2_f32_bf16 v208, v68, s64, v208
    v_dot2_f32_bf16 v210, v68, v68, v210
    v_dot2_f32_bf16 v208, v69, s64, v208
    v_dot2_f32_bf16 v210, v69, v69, v210
    v_dot2_f32_bf16 v208, v70, s64, v208
    v_dot2_f32_bf16 v210, v70, v70, v210
    v_dot2_f32_bf16 v208, v71, s64, v208
    v_dot2_f32_bf16 v210, v71, v71, v210
    v_mfma_f32_32x32x16_bf16 v[136:151], v[56:59], a[32:35], v[136:151]
    buffer_load_dwordx4 v9, s[24:27], s62 offen offset:1024 lds
    s_waitcnt vmcnt(6)
    ds_read_b128 v[72:75], v244 offset:12288
    ds_read_b128 v[76:79], v245 offset:12288
    ds_read_b128 v[80:83], v246 offset:12288
    ds_read_b128 v[84:87], v247 offset:12288
    v_mfma_f32_32x32x16_bf16 v[136:151], v[60:63], a[36:39], v[136:151]
    ds_read_b128 a[48:51], v204 offset:12288
    ds_read_b128 a[52:55], v204 offset:13312
    s_lshl_b32 s52, s52, 6
    s_add_u32 s52, s52, 1048576
    s_lshl_b32 s57, s57, 5
    s_add_u32 s57, s57, s45
    v_mfma_f32_32x32x16_bf16 v[136:151], v[64:67], a[40:43], v[136:151]
    buffer_load_dwordx4 v10, s[24:27], s62 offen offset:2048 lds
    s_lshl2_add_u32 s57, s57, 40960
    s_mul_i32 s49, s49, 0x9e3779b1
    s_add_u32 s49, s49, 0x7f4a7c15
    v_add_u32 v7, 168960, v4
    v_mfma_f32_32x32x16_bf16 v[136:151], v[68:71], a[44:47], v[136:151]
    s_branch L_page0
.p2align 12
L_page0:
L_padg0:
    s_cbranch_execz L_padg4
    s_waitcnt lgkmcnt(0)
    v_lshl_add_u32 v251, v2, 2, s56
    v_lshl_add_u32 v217, v3, 4, s56
    v_lshl_add_u32 v248, v3, 2, s44
    v_xor_b32 v248, v248, v201
    v_lshl_add_u32 v248, v2, 3, v248
    buffer_load_dwordx4 v11, s[24:27], s62 offen offset:3072 lds
    s_add_u32 m0, s60, 24576
    s_movk_i32 s62, 768
    v_dot2_f32_bf16 v208, v72, s64, v208
    v_dot2_f32_bf16 v210, v72, v72, v210
    v_dot2_f32_bf16 v208, v73, s64, v208
    v_dot2_f32_bf16 v210, v73, v73, v210
    v_dot2_f32_bf16 v208, v74, s64, v208
    v_dot2_f32_bf16 v210, v74, v74, v210
    v_dot2_f32_bf16 v208, v75, s64, v208
    v_dot2_f32_bf16 v210, v75, v75, v210
    v_dot2_f32_bf16 v208, v76, s64, v208
    v_dot2_f32_bf16 v210, v76, v76, v210
    v_dot2_f32_bf16 v208, v77, s64, v208
    v_dot2_f32_bf16 v210, v77, v77, v210
    v_dot2_f32_bf16 v208, v78, s64, v208
    v_dot2_f32_bf16 v210, v78, v78, v210
    v_dot2_f32_bf16 v208, v79, s64, v208
    v_dot2_f32_bf16 v210, v79, v79, v210
    buffer_load_dwordx4 v8, s[24:27], s62 offen offset:0 lds
    v_dot2_f32_bf16 v208, v80, s64, v208
    v_dot2_f32_bf16 v210, v80, v80, v210
    v_dot2_f32_bf16 v208, v81, s64, v208
    v_dot2_f32_bf16 v210, v81, v81, v210
    v_dot2_f32_bf16 v208, v82, s64, v208
    v_dot2_f32_bf16 v210, v82, v82, v210
    v_dot2_f32_bf16 v208, v83, s64, v208
    v_dot2_f32_bf16 v210, v83, v83, v210
    v_dot2_f32_bf16 v208, v84, s64, v208
    v_dot2_f32_bf16 v210, v84, v84, v210
    v_dot2_f32_bf16 v208, v85, s64, v208
    v_dot2_f32_bf16 v210, v85, v85, v210
    v_dot2_f32_bf16 v208, v86, s64, v208
    v_dot2_f32_bf16 v210, v86, v86, v210
    v_dot2_f32_bf16 v208, v87, s64, v208
    v_dot2_f32_bf16 v210, v87, v87, v210
    v_mfma_f32_32x32x16_bf16 v[136:151], v[72:75], a[48:51], v[136:151]
    buffer_load_dwordx4 v9, s[24:27], s62 offen offset:1024 lds
    s_waitcnt vmcnt(6)
    ds_read_b128 v[88:91], v244 offset:16384
    ds_read_b128 v[92:95], v245 offset:16384
    ds_read_b128 v[96:99], v246 offset:16384
    ds_read_b128 v[100:103], v247 offset:16384
    v_mfma_f32_32x32x16_bf16 v[136:151], v[76:79], a[52:55], v[136:151]
    v_lshlrev_b32 v248, 4, v248
    v_add_u32 v248, 147456, v248
    v_xor_b32 v249, v200, v0
    v_lshl_add_u32 v249, v249, 4, s54
    v_and_b32 v250, 4, v0
    v_mul_u32_u24 v250, 7, v250
    v_mfma_f32_32x32x16_bf16 v[152:167], v[80:83], a[0:3], 0
    buffer_load_dwordx4 v10, s[24:27], s62 offen offset:2048 lds
    v_add_u32 v250, v250, v201
    v_lshl_add_u32 v250, v200, 8, v250
    v_lshlrev_b32 v250, 4, v250
    v_mov_b32 v19, s49
    v_mfma_f32_32x32x16_bf16 v[152:167], v[84:87], a[4:7], v[152:167]
    s_waitcnt lgkmcnt(0)
    v_bfe_u32 v16, v0, 2, 2
    v_and_b32 v12, 16, v0
    v_lshlrev_b32 v12, 1, v12
    v_lshl_add_u32 v16, v16, 7, v12
    v_and_b32 v12, 11, v0
    buffer_load_dwordx4 v11, s[24:27], s62 offen offset:3072 lds
    v_dot2_f32_bf16 v208, v88, s64, v208
    v_dot2_f32_bf16 v210, v88, v88, v210
    v_dot2_f32_bf16 v208, v89, s64, v208
    v_dot2_f32_bf16 v210, v89, v89, v210
    v_dot2_f32_bf16 v208, v90, s64, v208
    v_dot2_f32_bf16 v210, v90, v90, v210
    v_dot2_f32_bf16 v208, v91, s64, v208
    v_dot2_f32_bf16 v210, v91, v91, v210
    v_dot2_f32_bf16 v208, v92, s64, v208
    v_dot2_f32_bf16 v210, v92, v92, v210
    v_dot2_f32_bf16 v208, v93, s64, v208
    v_dot2_f32_bf16 v210, v93, v93, v210
    v_dot2_f32_bf16 v208, v94, s64, v208
    v_dot2_f32_bf16 v210, v94, v94, v210
    v_dot2_f32_bf16 v208, v95, s64, v208
    v_dot2_f32_bf16 v210, v95, v95, v210
    v_dot2_f32_bf16 v208, v96, s64, v208
    v_dot2_f32_bf16 v210, v96, v96, v210
    v_dot2_f32_bf16 v208, v97, s64, v208
    v_dot2_f32_bf16 v210, v97, v97, v210
    v_dot2_f32_bf16 v208, v98, s64, v208
    v_dot2_f32_bf16 v210, v98, v98, v210
    v_dot2_f32_bf16 v208, v99, s64, v208
    v_dot2_f32_bf16 v210, v99, v99, v210
    v_dot2_f32_bf16 v208, v100, s64, v208
    v_dot2_f32_bf16 v210, v100, v100, v210
    v_dot2_f32_bf16 v208, v101, s64, v208
    v_dot2_f32_bf16 v210, v101, v101, v210
    v_dot2_f32_bf16 v208, v102, s64, v208
    v_dot2_f32_bf16 v210, v102, v102, v210
    v_dot2_f32_bf16 v208, v103, s64, v208
    v_dot2_f32_bf16 v210, v103, v103, v210
    v_mfma_f32_32x32x16_bf16 v[152:167], v[88:91], a[8:11], v[152:167]
    s_waitcnt vmcnt(4)
    ds_read_b128 v[104:107], v244 offset:20480
    ds_read_b128 v[108:111], v245 offset:20480
    ds_read_b128 v[112:115], v246 offset:20480
    ds_read_b128 v[116:119], v247 offset:20480
    v_lshl_add_u32 v16, v12, 3, v16
    v_mfma_f32_32x32x16_bf16 v[152:167], v[92:95], a[12:15], v[152:167]
    buffer_load_dword a178, v252, s[28:31], s66 offen
    buffer_load_dword a179, v252, s[28:31], s66 offen offset:128
    buffer_load_dword a180, v253, s[32:35], s67 offen
    v_mfma_f32_32x32x16_bf16 v[152:167], v[96:99], a[16:19], v[152:167]
    v_mul_u32_u24 v12, 28672, v3
    v_add_u32 v12, v12, v16
    v_add_u32 v14, 57344, v12
    v_mfma_f32_32x32x16_bf16 v[152:167], v[100:103], a[20:23], v[152:167]
    s_waitcnt lgkmcnt(0)
    v_dot2_f32_bf16 v208, v104, s64, v208
    v_dot2_f32_bf16 v210, v104, v104, v210
    v_dot2_f32_bf16 v208, v105, s64, v208
    v_dot2_f32_bf16 v210, v105, v105, v210
    v_dot2_f32_bf16 v208, v106, s64, v208
    v_dot2_f32_bf16 v210, v106, v106, v210
    v_dot2_f32_bf16 v208, v107, s64, v208
    v_dot2_f32_bf16 v210, v107, v107, v210
    v_dot2_f32_bf16 v208, v108, s64, v208
    v_dot2_f32_bf16 v210, v108, v108, v210
    v_dot2_f32_bf16 v208, v109, s64, v208
    v_dot2_f32_bf16 v210, v109, v109, v210
    v_dot2_f32_bf16 v208, v110, s64, v208
    v_dot2_f32_bf16 v210, v110, v110, v210
    v_dot2_f32_bf16 v208, v111, s64, v208
    v_dot2_f32_bf16 v210, v111, v111, v210
    v_dot2_f32_bf16 v208, v112, s64, v208
    v_dot2_f32_bf16 v210, v112, v112, v210
    v_dot2_f32_bf16 v208, v113, s64, v208
    v_dot2_f32_bf16 v210, v113, v113, v210
    v_dot2_f32_bf16 v208, v114, s64, v208
    v_dot2_f32_bf16 v210, v114, v114, v210
    v_dot2_f32_bf16 v208, v115, s64, v208
    v_dot2_f32_bf16 v210, v115, v115, v210
    v_dot2_f32_bf16 v208, v116, s64, v208
    v_dot2_f32_bf16 v210, v116, v116, v210
    v_dot2_f32_bf16 v208, v117, s64, v208
    v_dot2_f32_bf16 v210, v117, v117, v210
    v_dot2_f32_bf16 v208, v118, s64, v208
    v_dot2_f32_bf16 v210, v118, v118, v210
    v_dot2_f32_bf16 v208, v119, s64, v208
    v_dot2_f32_bf16 v210, v119, v119, v210
    v_mfma_f32_32x32x16_bf16 v[152:167], v[104:107], a[24:27], v[152:167]
    s_waitcnt vmcnt(3)
    ds_read_b128 v[120:123], v244 offset:24576
    ds_read_b128 v[124:127], v245 offset:24576
    ds_read_b128 v[128:131], v246 offset:24576
    ds_read_b128 v[132:135], v247 offset:24576
    v_mfma_f32_32x32x16_bf16 v[152:167], v[108:111], a[28:31], v[152:167]
    v_mfma_f32_32x32x16_bf16 v[152:167], v[112:115], a[32:35], v[152:167]
    v_mfma_f32_32x32x16_bf16 v[152:167], v[116:119], a[36:39], v[152:167]
    s_waitcnt lgkmcnt(0)
    v_dot2_f32_bf16 v208, v120, s64, v208
    v_dot2_f32_bf16 v210, v120, v120, v210
    v_dot2_f32_bf16 v208, v121, s64, v208
    v_dot2_f32_bf16 v210, v121, v121, v210
    v_dot2_f32_bf16 v208, v122, s64, v208
    v_dot2_f32_bf16 v210, v122, v122, v210
    v_dot2_f32_bf16 v208, v123, s64, v208
    v_dot2_f32_bf16 v210, v123, v123, v210
    v_dot2_f32_bf16 v208, v124, s64, v208
    v_dot2_f32_bf16 v210, v124, v124, v210
    v_dot2_f32_bf16 v208, v125, s64, v208
    v_dot2_f32_bf16 v210, v125, v125, v210
    v_dot2_f32_bf16 v208, v126, s64, v208
    v_dot2_f32_bf16 v210, v126, v126, v210
    v_dot2_f32_bf16 v208, v127, s64, v208
    v_dot2_f32_bf16 v210, v127, v127, v210
    v_dot2_f32_bf16 v208, v128, s64, v208
    v_dot2_f32_bf16 v210, v128, v128, v210
    v_dot2_f32_bf16 v208, v129, s64, v208
    v_dot2_f32_bf16 v210, v129, v129, v210
    v_dot2_f32_bf16 v208, v130, s64, v208
    v_dot2_f32_bf16 v210, v130, v130, v210
    v_dot2_f32_bf16 v208, v131, s64, v208
    v_dot2_f32_bf16 v210, v131, v131, v210
    v_dot2_f32_bf16 v208, v132, s64, v208
    v_dot2_f32_bf16 v210, v132, v132, v210
    v_dot2_f32_bf16 v208, v133, s64, v208
    v_dot2_f32_bf16 v210, v133, v133, v210
    v_dot2_f32_bf16 v208, v134, s64, v208
    v_dot2_f32_bf16 v210, v134, v134, v210
    v_dot2_f32_bf16 v208, v135, s64, v208
    v_dot2_f32_bf16 v210, v135, v135, v210
    v_mfma_f32_32x32x16_bf16 v[152:167], v[120:123], a[40:43], v[152:167]
    s_nop 0
    v_mov_b32 v209, v208
    v_mov_b32 v211, v210
    v_nop
    v_permlane32_swap_b32 v208, v209
    v_permlane32_swap_b32 v210, v211
    v_add_f32 v208, v208, v209
    v_mfma_f32_32x32x16_bf16 v[152:167], v[124:127], a[44:47], v[152:167]
    v_add_f32 v210, v210, v211
    v_mul_f32 v212, v207, v208
    v_mul_f32 v210, v207, v210
    v_fma_f32 v210, -v212, v212, v210
    v_max_f32 v210, 0, v210
    v_cvt_pk_bf16_f32 v212, v210, v212
    v_mfma_f32_32x32x16_bf16 v[152:167], v[128:131], a[48:51], v[152:167]
    v_lshlrev_b32 v210, 16, v212
    v_add_f32 v210, 0x3727c5ac, v210
    v_cvt_pk_bf16_f32 v210, 0, v210
    v_sqrt_f32 v210, v210
    v_and_b32 v212, 0xffff0000, v212
    v_mfma_f32_32x32x16_bf16 v[152:167], v[132:135], a[52:55], v[152:167]
    v_cvt_pk_bf16_f32 v210, 0, v210
    v_rcp_f32 v213, v210
    v_nop
    v_mul_f32 v208, 0x3b800000, v213
    ds_write_b32 v251, v208
    ds_read_b128 v[224:227], v217 offset:0
    ds_read_b128 v[228:231], v217 offset:32
    ds_read_b128 v[232:235], v217 offset:64
    ds_read_b128 v[236:239], v217 offset:96
    v_mul_f32 v214, 0x3fb8aa3b, v213
    v_cvt_pk_bf16_f32 v214, v214, 0
    v_lshlrev_b32 v215, 16, v214
    v_mul_f32 v216, -v212, v215
    v_mul_f32 v18, v215, v210
    v_mul_f32 v18, v18, v18
    v_pk_fma_f32 v[136:137], v[152:153], v[218:219], v[136:137] op_sel_hi:[1,0,1]
    v_pk_fma_f32 v[138:139], v[154:155], v[218:219], v[138:139] op_sel_hi:[1,0,1]
    v_pk_fma_f32 v[140:141], v[156:157], v[218:219], v[140:141] op_sel_hi:[1,0,1]
    v_pk_fma_f32 v[142:143], v[158:159], v[218:219], v[142:143] op_sel_hi:[1,0,1]
    v_pk_fma_f32 v[144:145], v[160:161], v[218:219], v[144:145] op_sel_hi:[1,0,1]
    v_pk_fma_f32 v[146:147], v[162:163], v[218:219], v[146:147] op_sel_hi:[1,0,1]
    v_pk_fma_f32 v[148:149], v[164:165], v[218:219], v[148:149] op_sel_hi:[1,0,1]
    v_pk_fma_f32 v[150:151], v[166:167], v[218:219], v[150:151] op_sel_hi:[1,0,1]
    v_dot2_f32_bf16 v168, v24, v214, v216
    v_dot2_f32_bf16 v169, v24, v215, v216
    v_dot2_f32_bf16 v170, v25, v214, v216
    v_dot2_f32_bf16 v171, v25, v215, v216
    v_dot2_f32_bf16 v172, v26, v214, v216
    v_dot2_f32_bf16 v173, v26, v215, v216
    v_dot2_f32_bf16 v174, v27, v214, v216
    v_dot2_f32_bf16 v175, v27, v215, v216
    v_cvt_pk_bf16_f32 v24, v168, v169
    v_cvt_pk_bf16_f32 v25, v170, v171
    s_waitcnt lgkmcnt(0)
    v_pk_mul_f32 v[136:137], v[136:137], v[224:225]
    v_pk_mul_f32 v[138:139], v[138:139], v[226:227]
    v_pk_mul_f32 v[140:141], v[140:141], v[228:229]
    v_pk_mul_f32 v[142:143], v[142:143], v[230:231]
    v_pk_mul_f32 v[144:145], v[144:145], v[232:233]
    v_pk_mul_f32 v[146:147], v[146:147], v[234:235]
    v_pk_mul_f32 v[148:149], v[148:149], v[236:237]
    v_pk_mul_f32 v[150:151], v[150:151], v[238:239]
    v_cvt_pk_f16_f32 v224, v136, v137
    v_cvt_pk_f16_f32 v225, v138, v139
    v_cvt_pk_f16_f32 v226, v140, v141
    v_cvt_pk_f16_f32 v227, v142, v143
    v_cvt_pk_f16_f32 v228, v144, v145
    v_cvt_pk_f16_f32 v229, v146, v147
    v_cvt_pk_f16_f32 v230, v148, v149
    v_cvt_pk_f16_f32 v231, v150, v151
    ds_write_b128 v248, v[224:227] offset:0
    ds_write_b128 v248, v[228:231] offset:4096
    v_dot2_f32_bf16 v168, v28, v214, v216
    v_dot2_f32_bf16 v169, v28, v215, v216
    v_dot2_f32_bf16 v170, v29, v214, v216
    v_dot2_f32_bf16 v171, v29, v215, v216
    v_cvt_pk_bf16_f32 v26, v172, v173
    v_cvt_pk_bf16_f32 v27, v174, v175
    v_dot2_f32_bf16 v172, v30, v214, v216
    v_dot2_f32_bf16 v173, v30, v215, v216
    v_dot2_f32_bf16 v174, v31, v214, v216
    v_dot2_f32_bf16 v175, v31, v215, v216
    v_cvt_pk_bf16_f32 v28, v168, v169
    v_cvt_pk_bf16_f32 v29, v170, v171
    s_waitcnt lgkmcnt(0)
    s_barrier
    ds_read_b128 v[232:235], v249 offset:0
    ds_read_b128 v[236:239], v249 offset:4096
    v_dot2_f32_bf16 v168, v32, v214, v216
    v_dot2_f32_bf16 v169, v32, v215, v216
    v_dot2_f32_bf16 v170, v33, v214, v216
    v_dot2_f32_bf16 v171, v33, v215, v216
    v_cvt_pk_bf16_f32 v30, v172, v173
    v_cvt_pk_bf16_f32 v31, v174, v175
    v_dot2_f32_bf16 v172, v34, v214, v216
    v_dot2_f32_bf16 v173, v34, v215, v216
    v_dot2_f32_bf16 v174, v35, v214, v216
    v_dot2_f32_bf16 v175, v35, v215, v216
    v_cvt_pk_bf16_f32 v32, v168, v169
    v_cvt_pk_bf16_f32 v33, v170, v171
    v_dot2_f32_bf16 v168, v36, v214, v216
    v_dot2_f32_bf16 v169, v36, v215, v216
    v_dot2_f32_bf16 v170, v37, v214, v216
    v_dot2_f32_bf16 v171, v37, v215, v216
    v_cvt_pk_bf16_f32 v34, v172, v173
    v_cvt_pk_bf16_f32 v35, v174, v175
    v_dot2_f32_bf16 v172, v38, v214, v216
    v_dot2_f32_bf16 v173, v38, v215, v216
    v_dot2_f32_bf16 v174, v39, v214, v216
    v_dot2_f32_bf16 v175, v39, v215, v216
    v_cvt_pk_bf16_f32 v36, v168, v169
    v_cvt_pk_bf16_f32 v37, v170, v171
    s_waitcnt lgkmcnt(0)
    buffer_store_dwordx4 v[232:235], v250, s[36:39], s52 offen offset:0 sc1
    buffer_store_dwordx4 v[236:239], v250, s[36:39], s52 offen offset:1024 sc1
    v_dot2_f32_bf16 v168, v40, v214, v216
    v_dot2_f32_bf16 v169, v40, v215, v216
    s_add_u32 m0, s60, 0
    s_nop 0
    buffer_load_dwordx4 v4, s[28:31], s72 offen offset:0 lds
    v_dot2_f32_bf16 v170, v41, v214, v216
    v_dot2_f32_bf16 v171, v41, v215, v216
    v_cvt_pk_bf16_f32 v38, v172, v173
    v_cvt_pk_bf16_f32 v39, v174, v175
    v_dot2_f32_bf16 v172, v42, v214, v216
    v_dot2_f32_bf16 v173, v42, v215, v216
    v_dot2_f32_bf16 v174, v43, v214, v216
    v_dot2_f32_bf16 v175, v43, v215, v216
    v_cvt_pk_bf16_f32 v40, v168, v169
    v_cvt_pk_bf16_f32 v41, v170, v171
    v_dot2_f32_bf16 v168, v44, v214, v216
    v_dot2_f32_bf16 v169, v44, v215, v216
    v_dot2_f32_bf16 v170, v45, v214, v216
    v_dot2_f32_bf16 v171, v45, v215, v216
    v_cvt_pk_bf16_f32 v42, v172, v173
    buffer_load_dwordx4 v5, s[28:31], s72 offen offset:1024 lds
    v_cvt_pk_bf16_f32 v43, v174, v175
    v_dot2_f32_bf16 v172, v46, v214, v216
    v_dot2_f32_bf16 v173, v46, v215, v216
    v_dot2_f32_bf16 v174, v47, v214, v216
    v_dot2_f32_bf16 v175, v47, v215, v216
    v_cvt_pk_bf16_f32 v44, v168, v169
    v_cvt_pk_bf16_f32 v45, v170, v171
    v_dot2_f32_bf16 v168, v48, v214, v216
    v_dot2_f32_bf16 v169, v48, v215, v216
    v_dot2_f32_bf16 v170, v49, v214, v216
    v_dot2_f32_bf16 v171, v49, v215, v216
    v_cvt_pk_bf16_f32 v46, v172, v173
    v_cvt_pk_bf16_f32 v47, v174, v175
    v_dot2_f32_bf16 v172, v50, v214, v216
    buffer_load_dwordx4 v6, s[28:31], s72 offen offset:2048 lds
    v_dot2_f32_bf16 v173, v50, v215, v216
    v_dot2_f32_bf16 v174, v51, v214, v216
    v_dot2_f32_bf16 v175, v51, v215, v216
    v_cvt_pk_bf16_f32 v48, v168, v169
    v_cvt_pk_bf16_f32 v49, v170, v171
    v_dot2_f32_bf16 v168, v52, v214, v216
    v_dot2_f32_bf16 v169, v52, v215, v216
    v_dot2_f32_bf16 v170, v53, v214, v216
    v_dot2_f32_bf16 v171, v53, v215, v216
    v_cvt_pk_bf16_f32 v50, v172, v173
    v_cvt_pk_bf16_f32 v51, v174, v175
    v_dot2_f32_bf16 v172, v54, v214, v216
    v_dot2_f32_bf16 v173, v54, v215, v216
    v_dot2_f32_bf16 v174, v55, v214, v216
    buffer_load_dwordx4 v7, s[28:31], s72 offen offset:3072 lds
    v_dot2_f32_bf16 v175, v55, v215, v216
    v_cvt_pk_bf16_f32 v52, v168, v169
    v_cvt_pk_bf16_f32 v53, v170, v171
    v_dot2_f32_bf16 v168, v56, v214, v216
    v_dot2_f32_bf16 v169, v56, v215, v216
    v_dot2_f32_bf16 v170, v57, v214, v216
    v_dot2_f32_bf16 v171, v57, v215, v216
    v_cvt_pk_bf16_f32 v54, v172, v173
    v_cvt_pk_bf16_f32 v55, v174, v175
    v_dot2_f32_bf16 v172, v58, v214, v216
    v_dot2_f32_bf16 v173, v58, v215, v216
    v_dot2_f32_bf16 v174, v59, v214, v216
    v_dot2_f32_bf16 v175, v59, v215, v216
    v_cvt_pk_bf16_f32 v56, v168, v169
    v_cvt_pk_bf16_f32 v57, v170, v171
    s_add_u32 m0, s60, 4096
    s_nop 0
    buffer_load_dwordx4 v4, s[28:31], s73 offen offset:0 lds
    v_dot2_f32_bf16 v168, v60, v214, v216
    v_dot2_f32_bf16 v169, v60, v215, v216
    v_dot2_f32_bf16 v170, v61, v214, v216
    v_dot2_f32_bf16 v171, v61, v215, v216
    v_cvt_pk_bf16_f32 v58, v172, v173
    v_cvt_pk_bf16_f32 v59, v174, v175
    v_dot2_f32_bf16 v172, v62, v214, v216
    v_dot2_f32_bf16 v173, v62, v215, v216
    v_dot2_f32_bf16 v174, v63, v214, v216
    v_dot2_f32_bf16 v175, v63, v215, v216
    v_cvt_pk_bf16_f32 v60, v168, v169
    v_cvt_pk_bf16_f32 v61, v170, v171
    v_dot2_f32_bf16 v168, v64, v214, v216
    v_dot2_f32_bf16 v169, v64, v215, v216
    buffer_load_dwordx4 v5, s[28:31], s73 offen offset:1024 lds
    v_dot2_f32_bf16 v170, v65, v214, v216
    v_dot2_f32_bf16 v171, v65, v215, v216
    v_cvt_pk_bf16_f32 v62, v172, v173
    v_cvt_pk_bf16_f32 v63, v174, v175
    v_dot2_f32_bf16 v172, v66, v214, v216
    v_dot2_f32_bf16 v173, v66, v215, v216
    v_dot2_f32_bf16 v174, v67, v214, v216
    v_dot2_f32_bf16 v175, v67, v215, v216
    v_cvt_pk_bf16_f32 v64, v168, v169
    v_cvt_pk_bf16_f32 v65, v170, v171
    v_dot2_f32_bf16 v168, v68, v214, v216
    v_dot2_f32_bf16 v169, v68, v215, v216
    v_dot2_f32_bf16 v170, v69, v214, v216
    v_dot2_f32_bf16 v171, v69, v215, v216
    buffer_load_dwordx4 v6, s[28:31], s73 offen offset:2048 lds
    v_cvt_pk_bf16_f32 v66, v172, v173
    v_cvt_pk_bf16_f32 v67, v174, v175
    v_dot2_f32_bf16 v172, v70, v214, v216
    v_dot2_f32_bf16 v173, v70, v215, v216
    v_dot2_f32_bf16 v174, v71, v214, v216
    v_dot2_f32_bf16 v175, v71, v215, v216
    v_cvt_pk_bf16_f32 v68, v168, v169
    v_cvt_pk_bf16_f32 v69, v170, v171
    v_dot2_f32_bf16 v168, v72, v214, v216
    v_dot2_f32_bf16 v169, v72, v215, v216
    v_dot2_f32_bf16 v170, v73, v214, v216
    v_dot2_f32_bf16 v171, v73, v215, v216
    v_cvt_pk_bf16_f32 v70, v172, v173
    v_cvt_pk_bf16_f32 v71, v174, v175
    v_dot2_f32_bf16 v172, v74, v214, v216
    buffer_load_dwordx4 v7, s[28:31], s73 offen offset:3072 lds
    v_dot2_f32_bf16 v173, v74, v215, v216
    v_dot2_f32_bf16 v174, v75, v214, v216
    v_dot2_f32_bf16 v175, v75, v215, v216
    v_cvt_pk_bf16_f32 v72, v168, v169
    v_cvt_pk_bf16_f32 v73, v170, v171
    v_dot2_f32_bf16 v168, v76, v214, v216
    v_dot2_f32_bf16 v169, v76, v215, v216
    v_dot2_f32_bf16 v170, v77, v214, v216
    v_dot2_f32_bf16 v171, v77, v215, v216
    v_cvt_pk_bf16_f32 v74, v172, v173
    v_cvt_pk_bf16_f32 v75, v174, v175
    v_dot2_f32_bf16 v172, v78, v214, v216
    v_dot2_f32_bf16 v173, v78, v215, v216
    v_dot2_f32_bf16 v174, v79, v214, v216
    s_add_u32 m0, s60, 8192
    s_nop 0
    buffer_load_dwordx4 v4, s[28:31], s74 offen offset:0 lds
    v_dot2_f32_bf16 v175, v79, v215, v216
    v_cvt_pk_bf16_f32 v76, v168, v169
    v_cvt_pk_bf16_f32 v77, v170, v171
    v_dot2_f32_bf16 v168, v80, v214, v216
    v_dot2_f32_bf16 v169, v80, v215, v216
    v_dot2_f32_bf16 v170, v81, v214, v216
    v_dot2_f32_bf16 v171, v81, v215, v216
    v_cvt_pk_bf16_f32 v78, v172, v173
    v_cvt_pk_bf16_f32 v79, v174, v175
    v_dot2_f32_bf16 v172, v82, v214, v216
    v_dot2_f32_bf16 v173, v82, v215, v216
    v_dot2_f32_bf16 v174, v83, v214, v216
    v_dot2_f32_bf16 v175, v83, v215, v216
    v_cvt_pk_bf16_f32 v80, v168, v169
    buffer_load_dwordx4 v5, s[28:31], s74 offen offset:1024 lds
    v_cvt_pk_bf16_f32 v81, v170, v171
    v_dot2_f32_bf16 v168, v84, v214, v216
    v_dot2_f32_bf16 v169, v84, v215, v216
    v_dot2_f32_bf16 v170, v85, v214, v216
    v_dot2_f32_bf16 v171, v85, v215, v216
    v_cvt_pk_bf16_f32 v82, v172, v173
    v_cvt_pk_bf16_f32 v83, v174, v175
    v_dot2_f32_bf16 v172, v86, v214, v216
    v_dot2_f32_bf16 v173, v86, v215, v216
    v_dot2_f32_bf16 v174, v87, v214, v216
    v_dot2_f32_bf16 v175, v87, v215, v216
    v_cvt_pk_bf16_f32 v84, v168, v169
    v_cvt_pk_bf16_f32 v85, v170, v171
    v_dot2_f32_bf16 v168, v88, v214, v216
    buffer_load_dwordx4 v6, s[28:31], s74 offen offset:2048 lds
    v_dot2_f32_bf16 v169, v88, v215, v216
    v_dot2_f32_bf16 v170, v89, v214, v216
    v_dot2_f32_bf16 v171, v89, v215, v216
    v_cvt_pk_bf16_f32 v86, v172, v173
    v_cvt_pk_bf16_f32 v87, v174, v175
    v_dot2_f32_bf16 v172, v90, v214, v216
    v_dot2_f32_bf16 v173, v90, v215, v216
    v_dot2_f32_bf16 v174, v91, v214, v216
    v_dot2_f32_bf16 v175, v91, v215, v216
    v_cvt_pk_bf16_f32 v88, v168, v169
    v_cvt_pk_bf16_f32 v89, v170, v171
    v_dot2_f32_bf16 v168, v92, v214, v216
    v_dot2_f32_bf16 v169, v92, v215, v216
    v_dot2_f32_bf16 v170, v93, v214, v216
    v_dot2_f32_bf16 v171, v93, v215, v216
    buffer_load_dwordx4 v7, s[28:31], s74 offen offset:3072 lds
    v_cvt_pk_bf16_f32 v90, v172, v173
    v_cvt_pk_bf16_f32 v91, v174, v175
    v_dot2_f32_bf16 v172, v94, v214, v216
    v_dot2_f32_bf16 v173, v94, v215, v216
    v_dot2_f32_bf16 v174, v95, v214, v216
    v_dot2_f32_bf16 v175, v95, v215, v216
    v_cvt_pk_bf16_f32 v92, v168, v169
    v_cvt_pk_bf16_f32 v93, v170, v171
    v_dot2_f32_bf16 v168, v96, v214, v216
    v_dot2_f32_bf16 v169, v96, v215, v216
    v_dot2_f32_bf16 v170, v97, v214, v216
    v_dot2_f32_bf16 v171, v97, v215, v216
    v_cvt_pk_bf16_f32 v94, v172, v173
    v_cvt_pk_bf16_f32 v95, v174, v175
    s_add_u32 m0, s60, 12288
    s_nop 0
    buffer_load_dwordx4 v4, s[28:31], s75 offen offset:0 lds
    s_waitcnt vmcnt(13)
    buffer_atomic_swap v19, v20, s[36:39], s57 offen offset:0 sc1
    v_dot2_f32_bf16 v172, v98, v214, v216
    v_dot2_f32_bf16 v173, v98, v215, v216
    v_dot2_f32_bf16 v174, v99, v214, v216
    v_dot2_f32_bf16 v175, v99, v215, v216
    v_cvt_pk_bf16_f32 v96, v168, v169
    v_cvt_pk_bf16_f32 v97, v170, v171
    v_dot2_f32_bf16 v168, v100, v214, v216
    v_dot2_f32_bf16 v169, v100, v215, v216
    v_dot2_f32_bf16 v170, v101, v214, v216
    v_dot2_f32_bf16 v171, v101, v215, v216
    v_cvt_pk_bf16_f32 v98, v172, v173
    v_cvt_pk_bf16_f32 v99, v174, v175
    v_dot2_f32_bf16 v172, v102, v214, v216
    v_dot2_f32_bf16 v173, v102, v215, v216
    buffer_load_dwordx4 v5, s[28:31], s75 offen offset:1024 lds
    v_dot2_f32_bf16 v174, v103, v214, v216
    v_dot2_f32_bf16 v175, v103, v215, v216
    v_cvt_pk_bf16_f32 v100, v168, v169
    v_cvt_pk_bf16_f32 v101, v170, v171
    v_dot2_f32_bf16 v168, v104, v214, v216
    v_dot2_f32_bf16 v169, v104, v215, v216
    v_dot2_f32_bf16 v170, v105, v214, v216
    v_dot2_f32_bf16 v171, v105, v215, v216
    v_cvt_pk_bf16_f32 v102, v172, v173
    v_cvt_pk_bf16_f32 v103, v174, v175
    v_dot2_f32_bf16 v172, v106, v214, v216
    v_dot2_f32_bf16 v173, v106, v215, v216
    v_dot2_f32_bf16 v174, v107, v214, v216
    v_dot2_f32_bf16 v175, v107, v215, v216
    v_cvt_pk_bf16_f32 v104, v168, v169
    buffer_load_dwordx4 v6, s[28:31], s75 offen offset:2048 lds
L_padg1:
    s_cbranch_execz L_backg
    v_cvt_pk_bf16_f32 v105, v170, v171
    v_dot2_f32_bf16 v168, v108, v214, v216
    v_dot2_f32_bf16 v169, v108, v215, v216
    v_dot2_f32_bf16 v170, v109, v214, v216
    v_dot2_f32_bf16 v171, v109, v215, v216
    v_cvt_pk_bf16_f32 v106, v172, v173
    v_cvt_pk_bf16_f32 v107, v174, v175
    v_dot2_f32_bf16 v172, v110, v214, v216
    v_dot2_f32_bf16 v173, v110, v215, v216
    v_dot2_f32_bf16 v174, v111, v214, v216
    v_dot2_f32_bf16 v175, v111, v215, v216
    v_cvt_pk_bf16_f32 v108, v168, v169
    v_cvt_pk_bf16_f32 v109, v170, v171
    v_dot2_f32_bf16 v168, v112, v214, v216
    buffer_load_dwordx4 v7, s[28:31], s75 offen offset:3072 lds
    v_dot2_f32_bf16 v169, v112, v215, v216
    v_dot2_f32_bf16 v170, v113, v214, v216
    v_dot2_f32_bf16 v171, v113, v215, v216
    v_cvt_pk_bf16_f32 v110, v172, v173
    v_cvt_pk_bf16_f32 v111, v174, v175
    v_dot2_f32_bf16 v172, v114, v214, v216
    v_dot2_f32_bf16 v173, v114, v215, v216
    v_dot2_f32_bf16 v174, v115, v214, v216
    v_dot2_f32_bf16 v175, v115, v215, v216
    v_cvt_pk_bf16_f32 v112, v168, v169
    v_cvt_pk_bf16_f32 v113, v170, v171
    v_dot2_f32_bf16 v168, v116, v214, v216
    v_dot2_f32_bf16 v169, v116, v215, v216
    v_dot2_f32_bf16 v170, v117, v214, v216
    s_add_u32 m0, s60, 16384
    s_nop 0
    buffer_load_dwordx4 v4, s[28:31], s76 offen offset:0 lds
    v_dot2_f32_bf16 v171, v117, v215, v216
    v_cvt_pk_bf16_f32 v114, v172, v173
    v_cvt_pk_bf16_f32 v115, v174, v175
    v_dot2_f32_bf16 v172, v118, v214, v216
    v_dot2_f32_bf16 v173, v118, v215, v216
    v_dot2_f32_bf16 v174, v119, v214, v216
    v_dot2_f32_bf16 v175, v119, v215, v216
    v_cvt_pk_bf16_f32 v116, v168, v169
    v_cvt_pk_bf16_f32 v117, v170, v171
    v_dot2_f32_bf16 v168, v120, v214, v216
    v_dot2_f32_bf16 v169, v120, v215, v216
    v_dot2_f32_bf16 v170, v121, v214, v216
    v_dot2_f32_bf16 v171, v121, v215, v216
    v_cvt_pk_bf16_f32 v118, v172, v173
    v_cvt_pk_bf16_f32 v119, v174, v175
    buffer_load_dwordx4 v5, s[28:31], s76 offen offset:1024 lds
    v_dot2_f32_bf16 v172, v122, v214, v216
    v_dot2_f32_bf16 v173, v122, v215, v216
    v_dot2_f32_bf16 v174, v123, v214, v216
    v_dot2_f32_bf16 v175, v123, v215, v216
    v_cvt_pk_bf16_f32 v120, v168, v169
    v_cvt_pk_bf16_f32 v121, v170, v171
    v_dot2_f32_bf16 v168, v124, v214, v216
    v_dot2_f32_bf16 v169, v124, v215, v216
    v_dot2_f32_bf16 v170, v125, v214, v216
    v_dot2_f32_bf16 v171, v125, v215, v216
    v_cvt_pk_bf16_f32 v122, v172, v173
    v_cvt_pk_bf16_f32 v123, v174, v175
    v_dot2_f32_bf16 v172, v126, v214, v216
    v_dot2_f32_bf16 v173, v126, v215, v216
    buffer_load_dwordx4 v6, s[28:31], s76 offen offset:2048 lds
    v_dot2_f32_bf16 v174, v127, v214, v216
    v_dot2_f32_bf16 v175, v127, v215, v216
    v_cvt_pk_bf16_f32 v124, v168, v169
    v_cvt_pk_bf16_f32 v125, v170, v171
    v_dot2_f32_bf16 v168, v128, v214, v216
    v_dot2_f32_bf16 v169, v128, v215, v216
    v_dot2_f32_bf16 v170, v129, v214, v216
    v_dot2_f32_bf16 v171, v129, v215, v216
    v_cvt_pk_bf16_f32 v126, v172, v173
    v_cvt_pk_bf16_f32 v127, v174, v175
    v_dot2_f32_bf16 v172, v130, v214, v216
    v_dot2_f32_bf16 v173, v130, v215, v216
    v_dot2_f32_bf16 v174, v131, v214, v216
    v_dot2_f32_bf16 v175, v131, v215, v216
    buffer_load_dwordx4 v7, s[28:31], s76 offen offset:3072 lds
    v_cvt_pk_bf16_f32 v128, v168, v169
    v_cvt_pk_bf16_f32 v129, v170, v171
    v_dot2_f32_bf16 v168, v132, v214, v216
    v_dot2_f32_bf16 v169, v132, v215, v216
    v_dot2_f32_bf16 v170, v133, v214, v216
    v_dot2_f32_bf16 v171, v133, v215, v216
    v_cvt_pk_bf16_f32 v130, v172, v173
    v_cvt_pk_bf16_f32 v131, v174, v175
    v_dot2_f32_bf16 v172, v134, v214, v216
    v_dot2_f32_bf16 v173, v134, v215, v216
    v_dot2_f32_bf16 v174, v135, v214, v216
    v_dot2_f32_bf16 v175, v135, v215, v216
    v_cvt_pk_bf16_f32 v132, v168, v169
    v_cvt_pk_bf16_f32 v133, v170, v171
    v_cvt_pk_bf16_f32 v134, v172, v173
    v_cvt_pk_bf16_f32 v135, v174, v175
    s_waitcnt vmcnt(9)
    s_barrier
    ds_read_b64_tr_b16 a[208:209], v12 offset:0
    ds_read_b64_tr_b16 a[210:211], v12 offset:512
    ds_read_b64_tr_b16 a[212:213], v14 offset:0
    ds_read_b64_tr_b16 a[214:215], v14 offset:512
    ds_read_b64_tr_b16 a[216:217], v12 offset:1024
    ds_read_b64_tr_b16 a[218:219], v12 offset:1536
    ds_read_b64_tr_b16 a[220:221], v14 offset:1024
    ds_read_b64_tr_b16 a[222:223], v14 offset:1536
    ds_read_b64_tr_b16 a[224:225], v12 offset:2048
    ds_read_b64_tr_b16 a[226:227], v12 offset:2560
    ds_read_b64_tr_b16 a[228:229], v14 offset:2048
    ds_read_b64_tr_b16 a[230:231], v14 offset:2560
    ds_read_b64_tr_b16 a[232:233], v12 offset:3072
    ds_read_b64_tr_b16 a[234:235], v12 offset:3584
    ds_read_b64_tr_b16 a[236:237], v14 offset:3072
    ds_read_b64_tr_b16 a[238:239], v14 offset:3584
    s_and_b32 s54, s44, 2
    s_mul_i32 s54, s54, 3
    s_add_u32 s54, s54, s44
    s_mul_i32 s54, s54, 14336
    s_lshl_b32 s55, s48, 7
    s_add_u32 s54, s54, s55
    s_mul_i32 s61, s44, 12288
    s_add_u32 s61, s61, 114688
    v_mul_u32_u24 v8, 896, v200
    v_add3_u32 v8, v8, v202, s54
    v_add_u32 v9, 6144, v8
    s_waitcnt lgkmcnt(8)
    v_mfma_f32_32x32x16_bf16 v[136:151], a[208:211], v[24:27], 0
    ds_read_b64_tr_b16 a[240:241], v12 offset:4096
    ds_read_b64_tr_b16 a[242:243], v12 offset:4608
    s_add_u32 m0, s60, 20480
    v_lshl_add_u32 v16, v3, 9, v16
    v_add_u32 v16, s61, v16
    v_xor_b32 v17, 64, v16
    v_mfma_f32_32x32x16_bf16 v[152:167], a[212:215], v[24:27], 0
    ds_read_b64_tr_b16 a[244:245], v14 offset:4096
    ds_read_b64_tr_b16 a[246:247], v14 offset:4608
    buffer_load_dwordx4 v4, s[28:31], s77 offen offset:0 lds
    v_xor_b32 v13, 64, v12
    v_xor_b32 v15, 64, v14
    v_mfma_f32_32x32x16_bf16 v[136:151], a[216:219], v[28:31], v[136:151]
    ds_read_b64_tr_b16 a[248:249], v12 offset:5120
    ds_read_b64_tr_b16 a[250:251], v12 offset:5632
    s_and_b32 s55, s46, 1
    s_lshr_b32 s56, s46, 1
    s_lshl3_add_u32 s54, s53, s55
    s_mul_i32 s54, s54, 14
    v_mfma_f32_32x32x16_bf16 v[152:167], a[220:223], v[28:31], v[152:167]
    ds_read_b64_tr_b16 a[252:253], v14 offset:5120
    ds_read_b64_tr_b16 a[254:255], v14 offset:5632
    s_waitcnt lgkmcnt(8)
    buffer_load_dwordx4 v5, s[28:31], s77 offen offset:1024 lds
    s_add_u32 s54, s54, s56
    v_mfma_f32_32x32x16_bf16 v[136:151], a[224:227], v[32:35], v[136:151]
    ds_read_b64_tr_b16 a[208:209], v12 offset:6144
    ds_read_b64_tr_b16 a[210:211], v12 offset:6656
    s_lshl_b32 s54, s54, 10
    s_add_u32 s59, s54, 6553600
    s_and_b32 s54, s53, 62
    s_add_u32 s54, s54, s55
    v_mfma_f32_32x32x16_bf16 v[152:167], a[228:231], v[32:35], v[152:167]
    ds_read_b64_tr_b16 a[212:213], v14 offset:6144
    ds_read_b64_tr_b16 a[214:215], v14 offset:6656
    buffer_load_dwordx4 v6, s[28:31], s77 offen offset:2048 lds
    s_lshl_b32 s54, s54, 7
    s_add_u32 s54, s54, s56
    v_mfma_f32_32x32x16_bf16 v[136:151], a[232:235], v[36:39], v[136:151]
    ds_read_b64_tr_b16 a[216:217], v12 offset:7168
    ds_read_b64_tr_b16 a[218:219], v12 offset:7680
    s_and_b32 s55, s53, 1
    s_mul_i32 s55, s55, 7
    s_add_u32 s54, s54, s55
    s_lshl2_add_u32 s57, s54, 4096
    v_mfma_f32_32x32x16_bf16 v[152:167], a[236:239], v[36:39], v[152:167]
    ds_read_b64_tr_b16 a[220:221], v14 offset:7168
    ds_read_b64_tr_b16 a[222:223], v14 offset:7680
    s_waitcnt lgkmcnt(8)
    buffer_load_dwordx4 v7, s[28:31], s77 offen offset:3072 lds
    v_add_u32 v21, 7168, v1
    v_mfma_f32_32x32x16_bf16 v[136:151], a[240:243], v[40:43], v[136:151]
    ds_read_b64_tr_b16 a[224:225], v12 offset:8192
    ds_read_b64_tr_b16 a[226:227], v12 offset:8704
    s_add_u32 m0, s60, 24576
    v_add_u32 v23, 50, v0
    v_and_b32 v23, 64, v23
    v_lshlrev_b32 v22, 2, v0
    v_mfma_f32_32x32x16_bf16 v[152:167], a[244:247], v[40:43], v[152:167]
    ds_read_b64_tr_b16 a[228:229], v14 offset:8192
    ds_read_b64_tr_b16 a[230:231], v14 offset:8704
    buffer_load_dwordx4 v4, s[28:31], s78 offen offset:0 lds
    v_lshl_add_u32 v22, v23, 24, v22
    v_mfma_f32_32x32x16_bf16 v[136:151], a[248:251], v[44:47], v[136:151]
    ds_read_b64_tr_b16 a[232:233], v12 offset:9216
    ds_read_b64_tr_b16 a[234:235], v12 offset:9728
    s_lshl_b32 s54, s47, 5
    s_add_u32 s54, s54, s44
    s_mul_i32 s54, s54, 7168
    s_add_u32 s54, s54, 6553600
    v_mfma_f32_32x32x16_bf16 v[152:167], a[252:255], v[44:47], v[152:167]
    ds_read_b64_tr_b16 a[236:237], v14 offset:9216
    ds_read_b64_tr_b16 a[238:239], v14 offset:9728
    s_waitcnt lgkmcnt(8)
    buffer_load_dwordx4 v5, s[28:31], s78 offen offset:1024 lds
    s_lshr_b32 s55, s44, 1
    v_mfma_f32_32x32x16_bf16 v[136:151], a[208:211], v[48:51], v[136:151]
    ds_read_b64_tr_b16 a[240:241], v12 offset:10240
    ds_read_b64_tr_b16 a[242:243], v12 offset:10752
    s_lshl1_add_u32 s55, s47, s55
    s_lshl_b32 s58, s55, 9
    s_add_u32 s58, s58, 4096
    s_movk_i32 s65, 4096
    v_mfma_f32_32x32x16_bf16 v[152:167], a[212:215], v[48:51], v[152:167]
    ds_read_b64_tr_b16 a[244:245], v14 offset:10240
    ds_read_b64_tr_b16 a[246:247], v14 offset:10752
    buffer_load_dwordx4 v6, s[28:31], s78 offen offset:2048 lds
    v_add_u32 v208, s54, v1
    v_add_u32 v209, 114688, v208
    v_mfma_f32_32x32x16_bf16 v[136:151], a[216:219], v[52:55], v[136:151]
    ds_read_b64_tr_b16 a[248:249], v12 offset:11264
    ds_read_b64_tr_b16 a[250:251], v12 offset:11776
    s_lshl2_add_u32 s54, s47, s44
    s_mul_i32 s54, s54, 14336
    s_add_u32 s54, s54, 2883584
    s_and_b32 s56, s44, 1
    v_mfma_f32_32x32x16_bf16 v[152:167], a[220:223], v[52:55], v[152:167]
    ds_read_b64_tr_b16 a[252:253], v14 offset:11264
    ds_read_b64_tr_b16 a[254:255], v14 offset:11776
    s_waitcnt lgkmcnt(8)
    buffer_load_dwordx4 v7, s[28:31], s78 offen offset:3072 lds
    s_lshl_b32 s56, s56, 10
    v_mfma_f32_32x32x16_bf16 v[136:151], a[224:227], v[56:59], v[136:151]
    s_waitcnt vmcnt(8)
    s_barrier
    ds_read_b64_tr_b16 a[208:209], v12 offset:12288
    ds_read_b64_tr_b16 a[210:211], v12 offset:12800
    s_add_u32 m0, s61, 0
    v_mfma_f32_32x32x16_bf16 v[152:167], a[228:231], v[56:59], v[152:167]
    ds_read_b64_tr_b16 a[212:213], v14 offset:12288
    ds_read_b64_tr_b16 a[214:215], v14 offset:12800
    buffer_load_dwordx4 v8, s[32:35], s72 offen offset:0 lds
    s_add_u32 s56, s56, s55
    s_mul_i32 s56, s56, 7
    v_mfma_f32_32x32x16_bf16 v[136:151], a[232:235], v[60:63], v[136:151]
    ds_read_b64_tr_b16 a[216:217], v12 offset:13312
    ds_read_b64_tr_b16 a[218:219], v12 offset:13824
    s_add_u32 s56, s56, s48
    s_lshl_b32 s56, s56, 7
    s_mov_b64 s[40:41], s[18:19]
    s_mov_b32 s42, 1835008
    v_mfma_f32_32x32x16_bf16 v[152:167], a[236:239], v[60:63], v[152:167]
    ds_read_b64_tr_b16 a[220:221], v14 offset:13312
    ds_read_b64_tr_b16 a[222:223], v14 offset:13824
    s_waitcnt lgkmcnt(8)
    buffer_load_dwordx4 v9, s[32:35], s72 offen offset:1024 lds
    s_mov_b32 s43, 0x20000
    v_mfma_f32_32x32x16_bf16 v[136:151], a[240:243], v[64:67], v[136:151]
    ds_read_b64_tr_b16 a[224:225], v12 offset:14336
    ds_read_b64_tr_b16 a[226:227], v12 offset:14848
    s_add_u32 m0, s61, 2048
    v_add_u32 v210, s54, v1
    v_add_u32 v211, 7168, v210
    v_lshrrev_b32 v212, 3, v0
    v_mfma_f32_32x32x16_bf16 v[152:167], a[244:247], v[64:67], v[152:167]
    ds_read_b64_tr_b16 a[228:229], v14 offset:14336
    ds_read_b64_tr_b16 a[230:231], v14 offset:14848
    buffer_load_dwordx4 v8, s[32:35], s73 offen offset:0 lds
    v_mul_u32_u24 v212, 57216, v212
    v_add3_u32 v212, v212, v1, s56
    v_mfma_f32_32x32x16_bf16 v[136:151], a[248:251], v[68:71], v[136:151]
    ds_read_b64_tr_b16 a[232:233], v12 offset:15360
    ds_read_b64_tr_b16 a[234:235], v12 offset:15872
    v_add_u32 v213, 458752, v212
    v_mfma_f32_32x32x16_bf16 v[152:167], a[252:255], v[68:71], v[152:167]
    ds_read_b64_tr_b16 a[236:237], v14 offset:15360
    ds_read_b64_tr_b16 a[238:239], v14 offset:15872
    s_waitcnt lgkmcnt(8)
    buffer_load_dwordx4 v9, s[32:35], s73 offen offset:1024 lds
    v_mfma_f32_32x32x16_bf16 v[136:151], a[208:211], v[72:75], v[136:151]
    ds_read_b64_tr_b16 a[240:241], v12 offset:16384
    ds_read_b64_tr_b16 a[242:243], v12 offset:16896
    s_add_u32 m0, s61, 4096
    v_mfma_f32_32x32x16_bf16 v[152:167], a[212:215], v[72:75], v[152:167]
    ds_read_b64_tr_b16 a[244:245], v14 offset:16384
    ds_read_b64_tr_b16 a[246:247], v14 offset:16896
    buffer_load_dwordx4 v8, s[32:35], s74 offen offset:0 lds
    v_mfma_f32_32x32x16_bf16 v[136:151], a[216:219], v[76:79], v[136:151]
    ds_read_b64_tr_b16 a[248:249], v12 offset:17408
    ds_read_b64_tr_b16 a[250:251], v12 offset:17920
    v_mfma_f32_32x32x16_bf16 v[152:167], a[220:223], v[76:79], v[152:167]
    ds_read_b64_tr_b16 a[252:253], v14 offset:17408
    ds_read_b64_tr_b16 a[254:255], v14 offset:17920
    s_waitcnt lgkmcnt(8)
    buffer_load_dwordx4 v9, s[32:35], s74 offen offset:1024 lds
    v_mfma_f32_32x32x16_bf16 v[136:151], a[224:227], v[80:83], v[136:151]
    ds_read_b64_tr_b16 a[208:209], v12 offset:18432
    ds_read_b64_tr_b16 a[210:211], v12 offset:18944
    s_add_u32 m0, s61, 6144
    v_mfma_f32_32x32x16_bf16 v[152:167], a[228:231], v[80:83], v[152:167]
    ds_read_b64_tr_b16 a[212:213], v14 offset:18432
    ds_read_b64_tr_b16 a[214:215], v14 offset:18944
    buffer_load_dwordx4 v8, s[32:35], s75 offen offset:0 lds
    v_mfma_f32_32x32x16_bf16 v[136:151], a[232:235], v[84:87], v[136:151]
    ds_read_b64_tr_b16 a[216:217], v12 offset:19456
    ds_read_b64_tr_b16 a[218:219], v12 offset:19968
    v_mfma_f32_32x32x16_bf16 v[152:167], a[236:239], v[84:87], v[152:167]
    ds_read_b64_tr_b16 a[220:221], v14 offset:19456
    ds_read_b64_tr_b16 a[222:223], v14 offset:19968
    s_waitcnt lgkmcnt(8)
    buffer_load_dwordx4 v9, s[32:35], s75 offen offset:1024 lds
    v_mfma_f32_32x32x16_bf16 v[136:151], a[240:243], v[88:91], v[136:151]
    s_waitcnt vmcnt(8)
    s_barrier
    ds_read_b64_tr_b16 a[224:225], v12 offset:20480
    ds_read_b64_tr_b16 a[226:227], v12 offset:20992
    s_add_u32 m0, s61, 8192
    v_mfma_f32_32x32x16_bf16 v[152:167], a[244:247], v[88:91], v[152:167]
    ds_read_b64_tr_b16 a[228:229], v14 offset:20480
    ds_read_b64_tr_b16 a[230:231], v14 offset:20992
    buffer_load_dwordx4 v8, s[32:35], s76 offen offset:0 lds
    v_mfma_f32_32x32x16_bf16 v[136:151], a[248:251], v[92:95], v[136:151]
    ds_read_b64_tr_b16 a[232:233], v12 offset:21504
    ds_read_b64_tr_b16 a[234:235], v12 offset:22016
    v_mfma_f32_32x32x16_bf16 v[152:167], a[252:255], v[92:95], v[152:167]
    ds_read_b64_tr_b16 a[236:237], v14 offset:21504
    ds_read_b64_tr_b16 a[238:239], v14 offset:22016
    s_waitcnt lgkmcnt(8)
    buffer_load_dwordx4 v9, s[32:35], s76 offen offset:1024 lds
    s_waitcnt vmcnt(8)
    ds_read_b64_tr_b16 a[0:1], v16 offset:0
    ds_read_b64_tr_b16 a[2:3], v16 offset:1024
    v_mfma_f32_32x32x16_bf16 v[136:151], a[208:211], v[96:99], v[136:151]
    ds_read_b64_tr_b16 a[240:241], v12 offset:22528
    ds_read_b64_tr_b16 a[242:243], v12 offset:23040
    s_add_u32 m0, s61, 10240
    ds_read_b64_tr_b16 a[4:5], v17 offset:0
    ds_read_b64_tr_b16 a[6:7], v17 offset:1024
    v_mfma_f32_32x32x16_bf16 v[152:167], a[212:215], v[96:99], v[152:167]
    ds_read_b64_tr_b16 a[244:245], v14 offset:22528
    ds_read_b64_tr_b16 a[246:247], v14 offset:23040
    buffer_load_dwordx4 v8, s[32:35], s77 offen offset:0 lds
    v_mfma_f32_32x32x16_bf16 v[136:151], a[216:219], v[100:103], v[136:151]
    ds_read_b64_tr_b16 a[248:249], v12 offset:23552
    ds_read_b64_tr_b16 a[250:251], v12 offset:24064
    v_mfma_f32_32x32x16_bf16 v[152:167], a[220:223], v[100:103], v[152:167]
    ds_read_b64_tr_b16 a[252:253], v14 offset:23552
    ds_read_b64_tr_b16 a[254:255], v14 offset:24064
    s_waitcnt lgkmcnt(12)
    buffer_load_dwordx4 v9, s[32:35], s77 offen offset:1024 lds
    s_waitcnt lgkmcnt(6)
    s_add_u32 m0, s61, 0
    v_mfma_f32_32x32x16_bf16 v[136:151], a[224:227], v[104:107], v[136:151]
    ds_read_b64_tr_b16 a[208:209], v12 offset:24576
    ds_read_b64_tr_b16 a[210:211], v12 offset:25088
    buffer_load_dwordx4 v8, s[32:35], s78 offen offset:0 lds
    s_waitcnt vmcnt(9)
    ds_read_b64_tr_b16 a[8:9], v16 offset:2048
    ds_read_b64_tr_b16 a[10:11], v16 offset:3072
    v_mfma_f32_32x32x16_bf16 v[152:167], a[228:231], v[104:107], v[152:167]
    ds_read_b64_tr_b16 a[212:213], v14 offset:24576
    ds_read_b64_tr_b16 a[214:215], v14 offset:25088
    ds_read_b64_tr_b16 a[12:13], v17 offset:2048
    ds_read_b64_tr_b16 a[14:15], v17 offset:3072
    v_mfma_f32_32x32x16_bf16 v[136:151], a[232:235], v[108:111], v[136:151]
    ds_read_b64_tr_b16 a[216:217], v12 offset:25600
    ds_read_b64_tr_b16 a[218:219], v12 offset:26112
    buffer_load_dwordx4 v9, s[32:35], s78 offen offset:1024 lds
    v_mfma_f32_32x32x16_bf16 v[152:167], a[236:239], v[108:111], v[152:167]
    ds_read_b64_tr_b16 a[220:221], v14 offset:25600
    ds_read_b64_tr_b16 a[222:223], v14 offset:26112
    s_waitcnt lgkmcnt(12)
    v_mfma_f32_32x32x16_bf16 v[136:151], a[240:243], v[112:115], v[136:151]
    ds_read_b64_tr_b16 a[224:225], v12 offset:26624
    ds_read_b64_tr_b16 a[226:227], v12 offset:27136
    s_waitcnt lgkmcnt(6)
    s_add_u32 m0, s61, 2048
    s_add_u32 s32, s32, 28672
    s_addc_u32 s33, s33, 0
    s_mov_b32 s34, 1576960
    s_waitcnt vmcnt(8)
    ds_read_b64_tr_b16 a[16:17], v16 offset:4096
    ds_read_b64_tr_b16 a[18:19], v16 offset:5120
    v_mfma_f32_32x32x16_bf16 v[152:167], a[244:247], v[112:115], v[152:167]
    ds_read_b64_tr_b16 a[228:229], v14 offset:26624
    ds_read_b64_tr_b16 a[230:231], v14 offset:27136
    buffer_load_dwordx4 v8, s[32:35], s72 offen offset:0 lds
    ds_read_b64_tr_b16 a[20:21], v17 offset:4096
    ds_read_b64_tr_b16 a[22:23], v17 offset:5120
    v_mfma_f32_32x32x16_bf16 v[136:151], a[248:251], v[116:119], v[136:151]
    ds_read_b64_tr_b16 a[232:233], v12 offset:27648
    ds_read_b64_tr_b16 a[234:235], v12 offset:28160
    v_mfma_f32_32x32x16_bf16 v[152:167], a[252:255], v[116:119], v[152:167]
    ds_read_b64_tr_b16 a[236:237], v14 offset:27648
    ds_read_b64_tr_b16 a[238:239], v14 offset:28160
    s_waitcnt lgkmcnt(12)
    buffer_load_dwordx4 v9, s[32:35], s72 offen offset:1024 lds
    v_mfma_f32_32x32x16_bf16 v[136:151], a[208:211], v[120:123], v[136:151]
    ds_read_b64_tr_b16 a[240:241], v13 offset:0
    ds_read_b64_tr_b16 a[242:243], v13 offset:512
    s_waitcnt lgkmcnt(6)
    s_add_u32 m0, s61, 4096
    s_waitcnt vmcnt(8)
    ds_read_b64_tr_b16 a[24:25], v16 offset:6144
    ds_read_b64_tr_b16 a[26:27], v16 offset:7168
    v_mfma_f32_32x32x16_bf16 v[152:167], a[212:215], v[120:123], v[152:167]
    ds_read_b64_tr_b16 a[244:245], v15 offset:0
    ds_read_b64_tr_b16 a[246:247], v15 offset:512
    buffer_load_dwordx4 v8, s[32:35], s73 offen offset:0 lds
    ds_read_b64_tr_b16 a[28:29], v17 offset:6144
    ds_read_b64_tr_b16 a[30:31], v17 offset:7168
    v_mfma_f32_32x32x16_bf16 v[136:151], a[216:219], v[124:127], v[136:151]
    ds_read_b64_tr_b16 a[248:249], v13 offset:1024
    ds_read_b64_tr_b16 a[250:251], v13 offset:1536
    v_mfma_f32_32x32x16_bf16 v[152:167], a[220:223], v[124:127], v[152:167]
    ds_read_b64_tr_b16 a[252:253], v15 offset:1024
    ds_read_b64_tr_b16 a[254:255], v15 offset:1536
    s_waitcnt lgkmcnt(12)
    buffer_load_dwordx4 v9, s[32:35], s73 offen offset:1024 lds
    v_mfma_f32_32x32x16_bf16 v[136:151], a[224:227], v[128:131], v[136:151]
    ds_read_b64_tr_b16 a[208:209], v13 offset:2048
    ds_read_b64_tr_b16 a[210:211], v13 offset:2560
    s_waitcnt lgkmcnt(6)
    s_add_u32 m0, s61, 6144
    s_waitcnt vmcnt(8)
    ds_read_b64_tr_b16 a[32:33], v16 offset:8192
    ds_read_b64_tr_b16 a[34:35], v16 offset:9216
    v_mfma_f32_32x32x16_bf16 v[152:167], a[228:231], v[128:131], v[152:167]
    ds_read_b64_tr_b16 a[212:213], v15 offset:2048
    ds_read_b64_tr_b16 a[214:215], v15 offset:2560
    buffer_load_dwordx4 v8, s[32:35], s74 offen offset:0 lds
    ds_read_b64_tr_b16 a[36:37], v17 offset:8192
    ds_read_b64_tr_b16 a[38:39], v17 offset:9216
    v_mfma_f32_32x32x16_bf16 v[136:151], a[232:235], v[132:135], v[136:151]
    ds_read_b64_tr_b16 a[216:217], v13 offset:3072
    ds_read_b64_tr_b16 a[218:219], v13 offset:3584
    v_mfma_f32_32x32x16_bf16 v[152:167], a[236:239], v[132:135], v[152:167]
    ds_read_b64_tr_b16 a[220:221], v15 offset:3072
    ds_read_b64_tr_b16 a[222:223], v15 offset:3584
    s_waitcnt lgkmcnt(12)
    buffer_load_dwordx4 v9, s[32:35], s74 offen offset:1024 lds
    s_waitcnt vmcnt(8)
    ds_read_b64_tr_b16 a[40:41], v16 offset:10240
    ds_read_b64_tr_b16 a[42:43], v16 offset:11264
    v_mfma_f32_32x32x16_bf16 v[168:183], a[240:243], v[24:27], 0
    ds_read_b64_tr_b16 a[224:225], v13 offset:4096
    ds_read_b64_tr_b16 a[226:227], v13 offset:4608
    s_waitcnt lgkmcnt(8)
    s_add_u32 m0, s61, 8192
    ds_read_b64_tr_b16 a[44:45], v17 offset:10240
    ds_read_b64_tr_b16 a[46:47], v17 offset:11264
    v_mfma_f32_32x32x16_bf16 v[184:199], a[244:247], v[24:27], 0
    ds_read_b64_tr_b16 a[228:229], v15 offset:4096
    ds_read_b64_tr_b16 a[230:231], v15 offset:4608
    buffer_load_dwordx4 v8, s[32:35], s75 offen offset:0 lds
    s_add_u32 s28, s28, 128
    s_addc_u32 s29, s29, 0
    s_mov_b32 s30, 1605504
    v_mfma_f32_32x32x16_bf16 v[168:183], a[248:251], v[28:31], v[168:183]
    ds_read_b64_tr_b16 a[232:233], v13 offset:5120
    ds_read_b64_tr_b16 a[234:235], v13 offset:5632
    v_mul_f32 v152, v136, v152
    v_mul_f32 v153, v137, v153
    v_exp_f32 v136, -v136
    v_mul_f32 v154, v138, v154
    v_mfma_f32_32x32x16_bf16 v[184:199], a[252:255], v[28:31], v[184:199]
    ds_read_b64_tr_b16 a[236:237], v15 offset:5120
    ds_read_b64_tr_b16 a[238:239], v15 offset:5632
    s_waitcnt lgkmcnt(12)
    buffer_load_dwordx4 v9, s[32:35], s75 offen offset:1024 lds
    s_waitcnt lgkmcnt(6)
    s_add_u32 m0, s61, 10240
    v_mfma_f32_32x32x16_bf16 v[168:183], a[208:211], v[32:35], v[168:183]
    s_barrier
    ds_read_b64_tr_b16 a[240:241], v13 offset:6144
    ds_read_b64_tr_b16 a[242:243], v13 offset:6656
    buffer_load_dwordx4 v8, s[32:35], s76 offen offset:0 lds
    v_fma_f32 v136, v136, v18, v18
    v_mfma_f32_32x32x16_bf16 v[184:199], a[212:215], v[32:35], v[184:199]
    ds_read_b64_tr_b16 a[244:245], v15 offset:6144
    ds_read_b64_tr_b16 a[246:247], v15 offset:6656
    v_exp_f32 v137, -v137
    v_rcp_f32 v136, v136
    v_fma_f32 v137, v137, v18, v18
    v_mfma_f32_32x32x16_bf16 v[168:183], a[216:219], v[36:39], v[168:183]
    ds_read_b64_tr_b16 a[248:249], v13 offset:7168
    ds_read_b64_tr_b16 a[250:251], v13 offset:7680
    buffer_load_dwordx4 v9, s[32:35], s76 offen offset:1024 lds
    v_rcp_f32 v137, v137
    v_mul_f32 v152, v152, v136
    v_mfma_f32_32x32x16_bf16 v[184:199], a[220:223], v[36:39], v[184:199]
    ds_read_b64_tr_b16 a[252:253], v15 offset:7168
    ds_read_b64_tr_b16 a[254:255], v15 offset:7680
    s_waitcnt lgkmcnt(8)
    s_add_u32 m0, s60, 0
    v_mul_f32 v153, v153, v137
    v_cvt_pk_bf16_f32 v200, v152, v153
    v_mul_f32 v155, v139, v155
    v_mfma_f32_32x32x16_bf16 v[168:183], a[224:227], v[40:43], v[168:183]
    ds_read_b64_tr_b16 a[208:209], v13 offset:8192
    ds_read_b64_tr_b16 a[210:211], v13 offset:8704
    buffer_load_dwordx4 v4, s[28:31], s72 offen offset:0 lds
    v_exp_f32 v138, -v138
    v_mul_f32 v156, v140, v156
    v_mfma_f32_32x32x16_bf16 v[184:199], a[228:231], v[40:43], v[184:199]
    ds_read_b64_tr_b16 a[212:213], v15 offset:8192
    ds_read_b64_tr_b16 a[214:215], v15 offset:8704
    v_exp_f32 v139, -v139
    v_fma_f32 v138, v138, v18, v18
    v_fma_f32 v139, v139, v18, v18
    v_mul_f32 v157, v141, v157
    v_mfma_f32_32x32x16_bf16 v[168:183], a[232:235], v[44:47], v[168:183]
    ds_read_b64_tr_b16 a[216:217], v13 offset:9216
    ds_read_b64_tr_b16 a[218:219], v13 offset:9728
    buffer_load_dwordx4 v5, s[28:31], s72 offen offset:1024 lds
    v_rcp_f32 v138, v138
    v_mul_f32 v158, v142, v158
    v_mfma_f32_32x32x16_bf16 v[184:199], a[236:239], v[44:47], v[184:199]
    ds_read_b64_tr_b16 a[220:221], v15 offset:9216
    ds_read_b64_tr_b16 a[222:223], v15 offset:9728
    s_waitcnt lgkmcnt(8)
    v_rcp_f32 v139, v139
    v_mul_f32 v154, v154, v138
    v_mul_f32 v155, v155, v139
    v_mfma_f32_32x32x16_bf16 v[168:183], a[240:243], v[48:51], v[168:183]
    s_barrier
    ds_read_b64_tr_b16 a[224:225], v13 offset:10240
    ds_read_b64_tr_b16 a[226:227], v13 offset:10752
    buffer_load_dwordx4 v6, s[28:31], s72 offen offset:2048 lds
    v_cvt_pk_bf16_f32 v201, v154, v155
    v_mfma_f32_32x32x16_bf16 v[184:199], a[244:247], v[48:51], v[184:199]
    ds_read_b64_tr_b16 a[228:229], v15 offset:10240
    ds_read_b64_tr_b16 a[230:231], v15 offset:10752
    v_exp_f32 v140, -v140
    v_exp_f32 v141, -v141
    v_fma_f32 v140, v140, v18, v18
    v_mfma_f32_32x32x16_bf16 v[168:183], a[248:251], v[52:55], v[168:183]
    ds_read_b64_tr_b16 a[232:233], v13 offset:11264
    ds_read_b64_tr_b16 a[234:235], v13 offset:11776
    buffer_load_dwordx4 v7, s[28:31], s72 offen offset:3072 lds
    v_fma_f32 v141, v141, v18, v18
    v_rcp_f32 v140, v140
    v_mfma_f32_32x32x16_bf16 v[184:199], a[252:255], v[52:55], v[184:199]
    ds_read_b64_tr_b16 a[236:237], v15 offset:11264
    ds_read_b64_tr_b16 a[238:239], v15 offset:11776
    s_waitcnt lgkmcnt(8)
    s_add_u32 m0, s60, 4096
    v_rcp_f32 v141, v141
    v_mul_f32 v156, v156, v140
    v_mfma_f32_32x32x16_bf16 v[168:183], a[208:211], v[56:59], v[168:183]
    ds_read_b64_tr_b16 a[240:241], v13 offset:12288
    ds_read_b64_tr_b16 a[242:243], v13 offset:12800
    buffer_load_dwordx4 v4, s[28:31], s73 offen offset:0 lds
    v_mul_f32 v157, v157, v141
    v_cvt_pk_bf16_f32 v202, v156, v157
    v_mul_f32 v159, v143, v159
    v_mfma_f32_32x32x16_bf16 v[184:199], a[212:215], v[56:59], v[184:199]
    ds_read_b64_tr_b16 a[244:245], v15 offset:12288
    ds_read_b64_tr_b16 a[246:247], v15 offset:12800
    v_exp_f32 v142, -v142
    v_exp_f32 v143, -v143
    v_fma_f32 v142, v142, v18, v18
    v_mfma_f32_32x32x16_bf16 v[168:183], a[216:219], v[60:63], v[168:183]
    ds_read_b64_tr_b16 a[248:249], v13 offset:13312
    ds_read_b64_tr_b16 a[250:251], v13 offset:13824
    buffer_load_dwordx4 v5, s[28:31], s73 offen offset:1024 lds
    v_fma_f32 v143, v143, v18, v18
    v_rcp_f32 v142, v142
    v_mfma_f32_32x32x16_bf16 v[184:199], a[220:223], v[60:63], v[184:199]
L_padg2:
    s_cbranch_execz L_backg
    ds_read_b64_tr_b16 a[252:253], v15 offset:13312
    ds_read_b64_tr_b16 a[254:255], v15 offset:13824
    s_waitcnt lgkmcnt(8)
    v_rcp_f32 v143, v143
    v_mul_f32 v158, v158, v142
    v_mul_f32 v159, v159, v143
    v_mfma_f32_32x32x16_bf16 v[168:183], a[224:227], v[64:67], v[168:183]
    s_barrier
    ds_read_b64_tr_b16 a[208:209], v13 offset:14336
    ds_read_b64_tr_b16 a[210:211], v13 offset:14848
    buffer_load_dwordx4 v6, s[28:31], s73 offen offset:2048 lds
    v_cvt_pk_bf16_f32 v203, v158, v159
    v_mfma_f32_32x32x16_bf16 v[184:199], a[228:231], v[64:67], v[184:199]
    ds_read_b64_tr_b16 a[212:213], v15 offset:14336
    ds_read_b64_tr_b16 a[214:215], v15 offset:14848
    v_mul_f32 v160, v144, v160
    v_mul_f32 v161, v145, v161
    v_exp_f32 v144, -v144
    v_mul_f32 v162, v146, v162
    v_mfma_f32_32x32x16_bf16 v[168:183], a[232:235], v[68:71], v[168:183]
    ds_read_b64_tr_b16 a[216:217], v13 offset:15360
    ds_read_b64_tr_b16 a[218:219], v13 offset:15872
    buffer_load_dwordx4 v7, s[28:31], s73 offen offset:3072 lds
    v_exp_f32 v145, -v145
    v_fma_f32 v144, v144, v18, v18
    v_mfma_f32_32x32x16_bf16 v[184:199], a[236:239], v[68:71], v[184:199]
    ds_read_b64_tr_b16 a[220:221], v15 offset:15360
    ds_read_b64_tr_b16 a[222:223], v15 offset:15872
    s_waitcnt lgkmcnt(8)
    s_add_u32 m0, s60, 8192
    v_fma_f32 v145, v145, v18, v18
    v_rcp_f32 v144, v144
    v_mfma_f32_32x32x16_bf16 v[168:183], a[240:243], v[72:75], v[168:183]
    ds_read_b64_tr_b16 a[224:225], v13 offset:16384
    ds_read_b64_tr_b16 a[226:227], v13 offset:16896
    buffer_load_dwordx4 v4, s[28:31], s74 offen offset:0 lds
    s_waitcnt vmcnt(19)
    ds_read_b64_tr_b16 a[48:49], v16 offset:0
    ds_read_b64_tr_b16 a[50:51], v16 offset:1024
    v_mfma_f32_32x32x16_bf16 v[184:199], a[244:247], v[72:75], v[184:199]
    ds_read_b64_tr_b16 a[228:229], v15 offset:16384
    ds_read_b64_tr_b16 a[230:231], v15 offset:16896
    ds_read_b64_tr_b16 a[52:53], v17 offset:0
    ds_read_b64_tr_b16 a[54:55], v17 offset:1024
    v_rcp_f32 v145, v145
    v_mul_f32 v160, v160, v144
    v_mfma_f32_32x32x16_bf16 v[168:183], a[248:251], v[76:79], v[168:183]
    ds_read_b64_tr_b16 a[232:233], v13 offset:17408
    ds_read_b64_tr_b16 a[234:235], v13 offset:17920
    buffer_load_dwordx4 v5, s[28:31], s74 offen offset:1024 lds
    v_mul_f32 v161, v161, v145
    v_cvt_pk_bf16_f32 v204, v160, v161
    v_mul_f32 v163, v147, v163
    v_mfma_f32_32x32x16_bf16 v[184:199], a[252:255], v[76:79], v[184:199]
    ds_read_b64_tr_b16 a[236:237], v15 offset:17408
    ds_read_b64_tr_b16 a[238:239], v15 offset:17920
    s_waitcnt lgkmcnt(12)
    v_exp_f32 v146, -v146
    v_exp_f32 v147, -v147
    v_mfma_f32_32x32x16_bf16 v[168:183], a[208:211], v[80:83], v[168:183]
    s_barrier
    ds_read_b64_tr_b16 a[240:241], v13 offset:18432
    ds_read_b64_tr_b16 a[242:243], v13 offset:18944
    buffer_load_dwordx4 v6, s[28:31], s74 offen offset:2048 lds
    v_fma_f32 v146, v146, v18, v18
    v_mfma_f32_32x32x16_bf16 v[184:199], a[212:215], v[80:83], v[184:199]
    ds_read_b64_tr_b16 a[244:245], v15 offset:18432
    ds_read_b64_tr_b16 a[246:247], v15 offset:18944
    s_waitcnt vmcnt(19)
    ds_read_b64_tr_b16 a[56:57], v16 offset:2048
    ds_read_b64_tr_b16 a[58:59], v16 offset:3072
    v_fma_f32 v147, v147, v18, v18
    v_mul_f32 v164, v148, v164
    v_mfma_f32_32x32x16_bf16 v[168:183], a[216:219], v[84:87], v[168:183]
    ds_read_b64_tr_b16 a[248:249], v13 offset:19456
    ds_read_b64_tr_b16 a[250:251], v13 offset:19968
    buffer_load_dwordx4 v7, s[28:31], s74 offen offset:3072 lds
    ds_read_b64_tr_b16 a[60:61], v17 offset:2048
    ds_read_b64_tr_b16 a[62:63], v17 offset:3072
    v_mul_f32 v165, v149, v165
    v_mfma_f32_32x32x16_bf16 v[184:199], a[220:223], v[84:87], v[184:199]
    ds_read_b64_tr_b16 a[252:253], v15 offset:19456
    ds_read_b64_tr_b16 a[254:255], v15 offset:19968
    s_waitcnt lgkmcnt(12)
    s_add_u32 m0, s60, 12288
    v_rcp_f32 v146, v146
    v_mul_f32 v166, v150, v166
    v_mfma_f32_32x32x16_bf16 v[168:183], a[224:227], v[88:91], v[168:183]
    ds_read_b64_tr_b16 a[208:209], v13 offset:20480
    ds_read_b64_tr_b16 a[210:211], v13 offset:20992
    buffer_load_dwordx4 v4, s[28:31], s75 offen offset:0 lds
    v_rcp_f32 v147, v147
    v_mul_f32 v162, v162, v146
    v_mfma_f32_32x32x16_bf16 v[184:199], a[228:231], v[88:91], v[184:199]
    ds_read_b64_tr_b16 a[212:213], v15 offset:20480
    ds_read_b64_tr_b16 a[214:215], v15 offset:20992
    s_waitcnt vmcnt(19)
    ds_read_b64_tr_b16 a[64:65], v16 offset:4096
    ds_read_b64_tr_b16 a[66:67], v16 offset:5120
    v_mul_f32 v163, v163, v147
    v_cvt_pk_bf16_f32 v205, v162, v163
    v_mfma_f32_32x32x16_bf16 v[168:183], a[232:235], v[92:95], v[168:183]
    ds_read_b64_tr_b16 a[216:217], v13 offset:21504
    ds_read_b64_tr_b16 a[218:219], v13 offset:22016
    buffer_load_dwordx4 v5, s[28:31], s75 offen offset:1024 lds
    ds_read_b64_tr_b16 a[68:69], v17 offset:4096
    ds_read_b64_tr_b16 a[70:71], v17 offset:5120
    v_mul_f32 v167, v151, v167
    v_mfma_f32_32x32x16_bf16 v[184:199], a[236:239], v[92:95], v[184:199]
    ds_read_b64_tr_b16 a[220:221], v15 offset:21504
    ds_read_b64_tr_b16 a[222:223], v15 offset:22016
    s_waitcnt lgkmcnt(12)
    v_exp_f32 v148, -v148
    v_exp_f32 v149, -v149
    v_mfma_f32_32x32x16_bf16 v[168:183], a[240:243], v[96:99], v[168:183]
    s_barrier
    ds_read_b64_tr_b16 a[224:225], v13 offset:22528
    ds_read_b64_tr_b16 a[226:227], v13 offset:23040
    buffer_load_dwordx4 v6, s[28:31], s75 offen offset:2048 lds
    v_fma_f32 v148, v148, v18, v18
    v_mfma_f32_32x32x16_bf16 v[184:199], a[244:247], v[96:99], v[184:199]
    ds_read_b64_tr_b16 a[228:229], v15 offset:22528
    ds_read_b64_tr_b16 a[230:231], v15 offset:23040
    s_waitcnt vmcnt(19)
    ds_read_b64_tr_b16 a[72:73], v16 offset:6144
    ds_read_b64_tr_b16 a[74:75], v16 offset:7168
    v_fma_f32 v149, v149, v18, v18
    v_mfma_f32_32x32x16_bf16 v[168:183], a[248:251], v[100:103], v[168:183]
    ds_read_b64_tr_b16 a[232:233], v13 offset:23552
    ds_read_b64_tr_b16 a[234:235], v13 offset:24064
    buffer_load_dwordx4 v7, s[28:31], s75 offen offset:3072 lds
    ds_read_b64_tr_b16 a[76:77], v17 offset:6144
    ds_read_b64_tr_b16 a[78:79], v17 offset:7168
    v_mfma_f32_32x32x16_bf16 v[184:199], a[252:255], v[100:103], v[184:199]
    ds_read_b64_tr_b16 a[236:237], v15 offset:23552
    ds_read_b64_tr_b16 a[238:239], v15 offset:24064
    s_waitcnt lgkmcnt(12)
    s_add_u32 m0, s60, 16384
    v_rcp_f32 v148, v148
    v_mfma_f32_32x32x16_bf16 v[168:183], a[208:211], v[104:107], v[168:183]
    ds_read_b64_tr_b16 a[240:241], v13 offset:24576
    ds_read_b64_tr_b16 a[242:243], v13 offset:25088
    buffer_load_dwordx4 v4, s[28:31], s76 offen offset:0 lds
    v_rcp_f32 v149, v149
    v_mul_f32 v164, v164, v148
    v_mfma_f32_32x32x16_bf16 v[184:199], a[212:215], v[104:107], v[184:199]
    ds_read_b64_tr_b16 a[244:245], v15 offset:24576
    ds_read_b64_tr_b16 a[246:247], v15 offset:25088
    s_waitcnt vmcnt(19)
    ds_read_b64_tr_b16 a[80:81], v16 offset:8192
    ds_read_b64_tr_b16 a[82:83], v16 offset:9216
    v_mul_f32 v165, v165, v149
    v_cvt_pk_bf16_f32 v206, v164, v165
    v_mfma_f32_32x32x16_bf16 v[168:183], a[216:219], v[108:111], v[168:183]
    ds_read_b64_tr_b16 a[248:249], v13 offset:25600
    ds_read_b64_tr_b16 a[250:251], v13 offset:26112
    buffer_load_dwordx4 v5, s[28:31], s76 offen offset:1024 lds
    ds_read_b64_tr_b16 a[84:85], v17 offset:8192
    ds_read_b64_tr_b16 a[86:87], v17 offset:9216
    v_mfma_f32_32x32x16_bf16 v[184:199], a[220:223], v[108:111], v[184:199]
    ds_read_b64_tr_b16 a[252:253], v15 offset:25600
    ds_read_b64_tr_b16 a[254:255], v15 offset:26112
    s_waitcnt lgkmcnt(12)
    buffer_load_dwordx4 v6, s[28:31], s76 offen offset:2048 lds
    v_exp_f32 v150, -v150
    v_mfma_f32_32x32x16_bf16 v[168:183], a[224:227], v[112:115], v[168:183]
    s_waitcnt vmcnt(11)
    s_barrier
    ds_read_b64_tr_b16 a[208:209], v13 offset:26624
    ds_read_b64_tr_b16 a[210:211], v13 offset:27136
    ds_read_b64_tr_b16 a[88:89], v16 offset:10240
    ds_read_b64_tr_b16 a[90:91], v16 offset:11264
    v_mfma_f32_32x32x16_bf16 v[184:199], a[228:231], v[112:115], v[184:199]
    ds_read_b64_tr_b16 a[212:213], v15 offset:26624
    ds_read_b64_tr_b16 a[214:215], v15 offset:27136
    buffer_load_dwordx4 v7, s[28:31], s76 offen offset:3072 lds
    ds_read_b64_tr_b16 a[92:93], v17 offset:10240
    ds_read_b64_tr_b16 a[94:95], v17 offset:11264
    v_fma_f32 v150, v150, v18, v18
    v_mfma_f32_32x32x16_bf16 v[168:183], a[232:235], v[116:119], v[168:183]
    ds_read_b64_tr_b16 a[216:217], v13 offset:27648
    ds_read_b64_tr_b16 a[218:219], v13 offset:28160
    s_add_u32 m0, s60, 20480
    v_exp_f32 v151, -v151
    v_rcp_f32 v150, v150
    v_mfma_f32_32x32x16_bf16 v[184:199], a[236:239], v[116:119], v[184:199]
    ds_read_b64_tr_b16 a[220:221], v15 offset:27648
    ds_read_b64_tr_b16 a[222:223], v15 offset:28160
    s_waitcnt lgkmcnt(12)
    buffer_load_dwordx4 v4, s[28:31], s77 offen offset:0 lds
    v_fma_f32 v151, v151, v18, v18
    v_mul_f32 v166, v166, v150
    v_rcp_f32 v151, v151
    s_nop 0
    v_mul_f32 v167, v167, v151
    v_cvt_pk_bf16_f32 v207, v166, v167
    v_mfma_f32_32x32x16_bf16 v[168:183], a[240:243], v[120:123], v[168:183]
    ds_read_b64_tr_b16 a[224:225], v12 offset:0
    ds_read_b64_tr_b16 a[226:227], v12 offset:512
    buffer_store_dwordx4 v[200:203], v1, s[36:39], s59 offen sc1
    v_mfma_f32_32x32x16_bf16 v[184:199], a[244:247], v[120:123], v[184:199]
    ds_read_b64_tr_b16 a[228:229], v14 offset:0
    ds_read_b64_tr_b16 a[230:231], v14 offset:512
    v_mfma_f32_32x32x16_bf16 v[168:183], a[248:251], v[124:127], v[168:183]
    ds_read_b64_tr_b16 a[232:233], v12 offset:1024
    ds_read_b64_tr_b16 a[234:235], v12 offset:1536
    buffer_store_dwordx4 v[204:207], v21, s[36:39], s59 offen sc1
    v_mfma_f32_32x32x16_bf16 v[184:199], a[252:255], v[124:127], v[184:199]
    ds_read_b64_tr_b16 a[236:237], v14 offset:1024
    ds_read_b64_tr_b16 a[238:239], v14 offset:1536
    s_waitcnt lgkmcnt(8)
    s_add_u32 s59, s59, 28672
    v_mfma_f32_32x32x16_bf16 v[168:183], a[208:211], v[128:131], v[168:183]
    s_waitcnt vmcnt(11)
    s_barrier
    ds_read_b64_tr_b16 a[240:241], v12 offset:2048
    ds_read_b64_tr_b16 a[242:243], v12 offset:2560
    v_mfma_f32_32x32x16_bf16 v[184:199], a[212:215], v[128:131], v[184:199]
    ds_read_b64_tr_b16 a[244:245], v14 offset:2048
    ds_read_b64_tr_b16 a[246:247], v14 offset:2560
    v_mfma_f32_32x32x16_bf16 v[168:183], a[216:219], v[132:135], v[168:183]
    ds_read_b64_tr_b16 a[248:249], v12 offset:3072
    ds_read_b64_tr_b16 a[250:251], v12 offset:3584
    buffer_load_dwordx4 v5, s[28:31], s77 offen offset:1024 lds
    v_mfma_f32_32x32x16_bf16 v[184:199], a[220:223], v[132:135], v[184:199]
    ds_read_b64_tr_b16 a[252:253], v14 offset:3072
    ds_read_b64_tr_b16 a[254:255], v14 offset:3584
    s_waitcnt lgkmcnt(8)
    v_mfma_f32_32x32x16_bf16 v[136:151], a[224:227], v[24:27], 0
    ds_read_b64_tr_b16 a[208:209], v12 offset:4096
    ds_read_b64_tr_b16 a[210:211], v12 offset:4608
    buffer_load_dwordx4 v6, s[28:31], s77 offen offset:2048 lds
    v_mfma_f32_32x32x16_bf16 v[152:167], a[228:231], v[24:27], 0
    ds_read_b64_tr_b16 a[212:213], v14 offset:4096
    ds_read_b64_tr_b16 a[214:215], v14 offset:4608
    v_mfma_f32_32x32x16_bf16 v[136:151], a[232:235], v[28:31], v[136:151]
    ds_read_b64_tr_b16 a[216:217], v12 offset:5120
    ds_read_b64_tr_b16 a[218:219], v12 offset:5632
    buffer_load_dwordx4 v7, s[28:31], s77 offen offset:3072 lds
    v_mul_f32 v184, v168, v184
    v_mul_f32 v185, v169, v185
    v_mul_f32 v186, v170, v186
    v_mfma_f32_32x32x16_bf16 v[152:167], a[236:239], v[28:31], v[152:167]
    ds_read_b64_tr_b16 a[220:221], v14 offset:5120
    ds_read_b64_tr_b16 a[222:223], v14 offset:5632
    s_waitcnt lgkmcnt(8)
    s_add_u32 m0, s60, 24576
    v_exp_f32 v168, -v168
    v_mul_f32 v187, v171, v187
    v_mfma_f32_32x32x16_bf16 v[136:151], a[240:243], v[32:35], v[136:151]
    ds_read_b64_tr_b16 a[224:225], v12 offset:6144
    ds_read_b64_tr_b16 a[226:227], v12 offset:6656
    buffer_load_dwordx4 v4, s[28:31], s78 offen offset:0 lds
    v_exp_f32 v169, -v169
    v_fma_f32 v168, v168, v18, v18
    v_mfma_f32_32x32x16_bf16 v[152:167], a[244:247], v[32:35], v[152:167]
    ds_read_b64_tr_b16 a[228:229], v14 offset:6144
    ds_read_b64_tr_b16 a[230:231], v14 offset:6656
    v_fma_f32 v169, v169, v18, v18
    v_rcp_f32 v168, v168
    v_rcp_f32 v169, v169
    v_mfma_f32_32x32x16_bf16 v[136:151], a[248:251], v[36:39], v[136:151]
    ds_read_b64_tr_b16 a[232:233], v12 offset:7168
    ds_read_b64_tr_b16 a[234:235], v12 offset:7680
    buffer_load_dwordx4 v5, s[28:31], s78 offen offset:1024 lds
    v_mul_f32 v184, v184, v168
    v_mul_f32 v185, v185, v169
    v_cvt_pk_bf16_f32 v200, v184, v185
    v_mfma_f32_32x32x16_bf16 v[152:167], a[252:255], v[36:39], v[152:167]
    ds_read_b64_tr_b16 a[236:237], v14 offset:7168
    ds_read_b64_tr_b16 a[238:239], v14 offset:7680
    s_waitcnt lgkmcnt(8)
    v_exp_f32 v170, -v170
    v_exp_f32 v171, -v171
    v_mfma_f32_32x32x16_bf16 v[136:151], a[208:211], v[40:43], v[136:151]
    ds_read_b64_tr_b16 a[240:241], v12 offset:8192
    ds_read_b64_tr_b16 a[242:243], v12 offset:8704
    buffer_load_dwordx4 v6, s[28:31], s78 offen offset:2048 lds
    v_fma_f32 v170, v170, v18, v18
    v_fma_f32 v171, v171, v18, v18
    v_mul_f32 v188, v172, v188
    v_mfma_f32_32x32x16_bf16 v[152:167], a[212:215], v[40:43], v[152:167]
    ds_read_b64_tr_b16 a[244:245], v14 offset:8192
    ds_read_b64_tr_b16 a[246:247], v14 offset:8704
    v_rcp_f32 v170, v170
    v_rcp_f32 v171, v171
    v_mul_f32 v186, v186, v170
    v_mfma_f32_32x32x16_bf16 v[136:151], a[216:219], v[44:47], v[136:151]
    ds_read_b64_tr_b16 a[248:249], v12 offset:9216
    ds_read_b64_tr_b16 a[250:251], v12 offset:9728
    buffer_load_dwordx4 v7, s[28:31], s78 offen offset:3072 lds
    v_mul_f32 v187, v187, v171
    v_cvt_pk_bf16_f32 v201, v186, v187
    v_mul_f32 v189, v173, v189
    v_mfma_f32_32x32x16_bf16 v[152:167], a[220:223], v[44:47], v[152:167]
    ds_read_b64_tr_b16 a[252:253], v14 offset:9216
    ds_read_b64_tr_b16 a[254:255], v14 offset:9728
    s_waitcnt lgkmcnt(8)
    s_add_u32 m0, s61, 0
    v_exp_f32 v172, -v172
    v_mfma_f32_32x32x16_bf16 v[136:151], a[224:227], v[48:51], v[136:151]
    ds_read_b64_tr_b16 a[208:209], v12 offset:10240
    ds_read_b64_tr_b16 a[210:211], v12 offset:10752
    buffer_load_dwordx4 v8, s[32:35], s77 offen offset:0 lds
    v_exp_f32 v173, -v173
    v_fma_f32 v172, v172, v18, v18
    v_mfma_f32_32x32x16_bf16 v[152:167], a[228:231], v[48:51], v[152:167]
    ds_read_b64_tr_b16 a[212:213], v14 offset:10240
    ds_read_b64_tr_b16 a[214:215], v14 offset:10752
    v_fma_f32 v173, v173, v18, v18
    v_rcp_f32 v172, v172
    v_rcp_f32 v173, v173
    v_mfma_f32_32x32x16_bf16 v[136:151], a[232:235], v[52:55], v[136:151]
    ds_read_b64_tr_b16 a[216:217], v12 offset:11264
    ds_read_b64_tr_b16 a[218:219], v12 offset:11776
    buffer_load_dwordx4 v9, s[32:35], s77 offen offset:1024 lds
    v_mul_f32 v188, v188, v172
    v_mul_f32 v189, v189, v173
    v_cvt_pk_bf16_f32 v202, v188, v189
    v_mfma_f32_32x32x16_bf16 v[152:167], a[236:239], v[52:55], v[152:167]
    ds_read_b64_tr_b16 a[220:221], v14 offset:11264
    ds_read_b64_tr_b16 a[222:223], v14 offset:11776
    s_waitcnt lgkmcnt(8)
    s_waitcnt vmcnt(9)
    buffer_atomic_swap v19, v20, s[36:39], s57 offen offset:0 sc1
    v_mfma_f32_32x32x16_bf16 v[136:151], a[240:243], v[56:59], v[136:151]
    s_barrier
    ds_read_b64_tr_b16 a[224:225], v12 offset:12288
    ds_read_b64_tr_b16 a[226:227], v12 offset:12800
    s_add_u32 m0, s61, 2048
    v_mfma_f32_32x32x16_bf16 v[152:167], a[244:247], v[56:59], v[152:167]
    ds_read_b64_tr_b16 a[228:229], v14 offset:12288
    ds_read_b64_tr_b16 a[230:231], v14 offset:12800
    buffer_load_dwordx4 v8, s[32:35], s78 offen offset:0 lds
    v_mul_f32 v190, v174, v190
    v_mul_f32 v191, v175, v191
    v_mul_f32 v192, v176, v192
    v_mfma_f32_32x32x16_bf16 v[136:151], a[248:251], v[60:63], v[136:151]
    ds_read_b64_tr_b16 a[232:233], v12 offset:13312
    ds_read_b64_tr_b16 a[234:235], v12 offset:13824
    v_exp_f32 v174, -v174
    v_exp_f32 v175, -v175
    v_fma_f32 v174, v174, v18, v18
    v_mfma_f32_32x32x16_bf16 v[152:167], a[252:255], v[60:63], v[152:167]
    ds_read_b64_tr_b16 a[236:237], v14 offset:13312
    ds_read_b64_tr_b16 a[238:239], v14 offset:13824
    s_waitcnt lgkmcnt(8)
    buffer_load_dwordx4 v9, s[32:35], s78 offen offset:1024 lds
    s_add_u32 m0, s61, 4096
    s_add_u32 s32, s32, 28672
    s_addc_u32 s33, s33, 0
    s_mov_b32 s34, 1548288
    v_mfma_f32_32x32x16_bf16 v[136:151], a[208:211], v[64:67], v[136:151]
    ds_read_b64_tr_b16 a[240:241], v12 offset:14336
    ds_read_b64_tr_b16 a[242:243], v12 offset:14848
    buffer_load_dwordx4 v8, s[32:35], s72 offen offset:0 lds
    v_fma_f32 v175, v175, v18, v18
    v_rcp_f32 v174, v174
    v_mfma_f32_32x32x16_bf16 v[152:167], a[212:215], v[64:67], v[152:167]
    ds_read_b64_tr_b16 a[244:245], v14 offset:14336
    ds_read_b64_tr_b16 a[246:247], v14 offset:14848
    v_rcp_f32 v175, v175
    v_mul_f32 v190, v190, v174
    v_mul_f32 v191, v191, v175
    v_cvt_pk_bf16_f32 v203, v190, v191
    v_mfma_f32_32x32x16_bf16 v[136:151], a[216:219], v[68:71], v[136:151]
    ds_read_b64_tr_b16 a[248:249], v12 offset:15360
    ds_read_b64_tr_b16 a[250:251], v12 offset:15872
    buffer_load_dwordx4 v9, s[32:35], s72 offen offset:1024 lds
    v_mul_f32 v193, v177, v193
    v_exp_f32 v176, -v176
    v_mfma_f32_32x32x16_bf16 v[152:167], a[220:223], v[68:71], v[152:167]
    ds_read_b64_tr_b16 a[252:253], v14 offset:15360
    ds_read_b64_tr_b16 a[254:255], v14 offset:15872
    s_waitcnt lgkmcnt(8)
    s_add_u32 m0, s61, 6144
    v_exp_f32 v177, -v177
    v_mfma_f32_32x32x16_bf16 v[136:151], a[224:227], v[72:75], v[136:151]
    ds_read_b64_tr_b16 a[208:209], v12 offset:16384
    ds_read_b64_tr_b16 a[210:211], v12 offset:16896
    buffer_load_dwordx4 v8, s[32:35], s73 offen offset:0 lds
    v_fma_f32 v176, v176, v18, v18
    v_fma_f32 v177, v177, v18, v18
    v_mul_f32 v194, v178, v194
    v_mfma_f32_32x32x16_bf16 v[152:167], a[228:231], v[72:75], v[152:167]
    ds_read_b64_tr_b16 a[212:213], v14 offset:16384
    ds_read_b64_tr_b16 a[214:215], v14 offset:16896
    v_rcp_f32 v176, v176
    v_rcp_f32 v177, v177
    v_mul_f32 v192, v192, v176
    v_mfma_f32_32x32x16_bf16 v[136:151], a[232:235], v[76:79], v[136:151]
    ds_read_b64_tr_b16 a[216:217], v12 offset:17408
    ds_read_b64_tr_b16 a[218:219], v12 offset:17920
    buffer_load_dwordx4 v9, s[32:35], s73 offen offset:1024 lds
    v_mul_f32 v193, v193, v177
    v_cvt_pk_bf16_f32 v204, v192, v193
    v_mul_f32 v195, v179, v195
    v_mfma_f32_32x32x16_bf16 v[152:167], a[236:239], v[76:79], v[152:167]
    ds_read_b64_tr_b16 a[220:221], v14 offset:17408
    ds_read_b64_tr_b16 a[222:223], v14 offset:17920
    s_waitcnt lgkmcnt(8)
    s_add_u32 m0, s61, 8192
    v_exp_f32 v178, -v178
    v_mfma_f32_32x32x16_bf16 v[136:151], a[240:243], v[80:83], v[136:151]
    ds_read_b64_tr_b16 a[224:225], v12 offset:18432
    ds_read_b64_tr_b16 a[226:227], v12 offset:18944
    buffer_load_dwordx4 v8, s[32:35], s74 offen offset:0 lds
    v_exp_f32 v179, -v179
    v_fma_f32 v178, v178, v18, v18
    v_mfma_f32_32x32x16_bf16 v[152:167], a[244:247], v[80:83], v[152:167]
    ds_read_b64_tr_b16 a[228:229], v14 offset:18432
    ds_read_b64_tr_b16 a[230:231], v14 offset:18944
    v_fma_f32 v179, v179, v18, v18
    v_rcp_f32 v178, v178
    v_rcp_f32 v179, v179
    v_mfma_f32_32x32x16_bf16 v[136:151], a[248:251], v[84:87], v[136:151]
    ds_read_b64_tr_b16 a[232:233], v12 offset:19456
    ds_read_b64_tr_b16 a[234:235], v12 offset:19968
    buffer_load_dwordx4 v9, s[32:35], s74 offen offset:1024 lds
    v_mul_f32 v194, v194, v178
    v_mul_f32 v195, v195, v179
    v_cvt_pk_bf16_f32 v205, v194, v195
    v_mfma_f32_32x32x16_bf16 v[152:167], a[252:255], v[84:87], v[152:167]
    ds_read_b64_tr_b16 a[236:237], v14 offset:19456
    ds_read_b64_tr_b16 a[238:239], v14 offset:19968
    s_waitcnt lgkmcnt(8)
    s_add_u32 m0, s61, 10240
    s_waitcnt vmcnt(9)
    ds_read_b64_tr_b16 a[96:97], v16 offset:0
    ds_read_b64_tr_b16 a[98:99], v16 offset:1024
    v_mfma_f32_32x32x16_bf16 v[136:151], a[208:211], v[88:91], v[136:151]
    s_barrier
    ds_read_b64_tr_b16 a[240:241], v12 offset:20480
    ds_read_b64_tr_b16 a[242:243], v12 offset:20992
    buffer_load_dwordx4 v8, s[32:35], s75 offen offset:0 lds
    ds_read_b64_tr_b16 a[100:101], v17 offset:0
    ds_read_b64_tr_b16 a[102:103], v17 offset:1024
    v_mfma_f32_32x32x16_bf16 v[152:167], a[212:215], v[88:91], v[152:167]
    ds_read_b64_tr_b16 a[244:245], v14 offset:20480
    ds_read_b64_tr_b16 a[246:247], v14 offset:20992
    v_mul_f32 v196, v180, v196
    v_mul_f32 v197, v181, v197
    v_exp_f32 v180, -v180
    v_mul_f32 v198, v182, v198
    v_mfma_f32_32x32x16_bf16 v[136:151], a[216:219], v[92:95], v[136:151]
    ds_read_b64_tr_b16 a[248:249], v12 offset:21504
    ds_read_b64_tr_b16 a[250:251], v12 offset:22016
    buffer_load_dwordx4 v9, s[32:35], s75 offen offset:1024 lds
    v_exp_f32 v181, -v181
    v_fma_f32 v180, v180, v18, v18
    v_mfma_f32_32x32x16_bf16 v[152:167], a[220:223], v[92:95], v[152:167]
    ds_read_b64_tr_b16 a[252:253], v14 offset:21504
    ds_read_b64_tr_b16 a[254:255], v14 offset:22016
    s_waitcnt lgkmcnt(12)
    s_waitcnt lgkmcnt(6)
    s_add_u32 m0, s61, 0
    v_fma_f32 v181, v181, v18, v18
    v_mul_f32 v199, v183, v199
    v_mfma_f32_32x32x16_bf16 v[136:151], a[224:227], v[96:99], v[136:151]
    ds_read_b64_tr_b16 a[208:209], v12 offset:22528
    ds_read_b64_tr_b16 a[210:211], v12 offset:23040
    buffer_load_dwordx4 v8, s[32:35], s76 offen offset:0 lds
    s_waitcnt vmcnt(9)
    ds_read_b64_tr_b16 a[104:105], v16 offset:2048
    ds_read_b64_tr_b16 a[106:107], v16 offset:3072
    v_mfma_f32_32x32x16_bf16 v[152:167], a[228:231], v[96:99], v[152:167]
    ds_read_b64_tr_b16 a[212:213], v14 offset:22528
    ds_read_b64_tr_b16 a[214:215], v14 offset:23040
    ds_read_b64_tr_b16 a[108:109], v17 offset:2048
    ds_read_b64_tr_b16 a[110:111], v17 offset:3072
    v_rcp_f32 v180, v180
    v_mfma_f32_32x32x16_bf16 v[136:151], a[232:235], v[100:103], v[136:151]
    ds_read_b64_tr_b16 a[216:217], v12 offset:23552
    ds_read_b64_tr_b16 a[218:219], v12 offset:24064
    buffer_load_dwordx4 v9, s[32:35], s76 offen offset:1024 lds
    v_rcp_f32 v181, v181
    v_mul_f32 v196, v196, v180
    v_mfma_f32_32x32x16_bf16 v[152:167], a[236:239], v[100:103], v[152:167]
    ds_read_b64_tr_b16 a[220:221], v14 offset:23552
    ds_read_b64_tr_b16 a[222:223], v14 offset:24064
    s_waitcnt lgkmcnt(12)
    v_mul_f32 v197, v197, v181
    v_cvt_pk_bf16_f32 v206, v196, v197
    v_exp_f32 v182, -v182
    v_mfma_f32_32x32x16_bf16 v[136:151], a[240:243], v[104:107], v[136:151]
    ds_read_b64_tr_b16 a[224:225], v12 offset:24576
    ds_read_b64_tr_b16 a[226:227], v12 offset:25088
    s_waitcnt lgkmcnt(6)
    s_add_u32 m0, s61, 2048
    s_waitcnt vmcnt(8)
    ds_read_b64_tr_b16 a[112:113], v16 offset:4096
    ds_read_b64_tr_b16 a[114:115], v16 offset:5120
    v_mfma_f32_32x32x16_bf16 v[152:167], a[244:247], v[104:107], v[152:167]
    ds_read_b64_tr_b16 a[228:229], v14 offset:24576
    ds_read_b64_tr_b16 a[230:231], v14 offset:25088
    buffer_load_dwordx4 v8, s[32:35], s77 offen offset:0 lds
    ds_read_b64_tr_b16 a[116:117], v17 offset:4096
    ds_read_b64_tr_b16 a[118:119], v17 offset:5120
    v_fma_f32 v182, v182, v18, v18
    v_mfma_f32_32x32x16_bf16 v[136:151], a[248:251], v[108:111], v[136:151]
    ds_read_b64_tr_b16 a[232:233], v12 offset:25600
    ds_read_b64_tr_b16 a[234:235], v12 offset:26112
    v_exp_f32 v183, -v183
    v_rcp_f32 v182, v182
    v_fma_f32 v183, v183, v18, v18
    v_mfma_f32_32x32x16_bf16 v[152:167], a[252:255], v[108:111], v[152:167]
    ds_read_b64_tr_b16 a[236:237], v14 offset:25600
    ds_read_b64_tr_b16 a[238:239], v14 offset:26112
    s_waitcnt lgkmcnt(12)
    buffer_load_dwordx4 v9, s[32:35], s77 offen offset:1024 lds
    v_rcp_f32 v183, v183
    v_mfma_f32_32x32x16_bf16 v[136:151], a[208:211], v[112:115], v[136:151]
    ds_read_b64_tr_b16 a[240:241], v12 offset:26624
    ds_read_b64_tr_b16 a[242:243], v12 offset:27136
    s_waitcnt lgkmcnt(6)
    s_add_u32 m0, s61, 4096
    v_mul_f32 v198, v198, v182
    v_mul_f32 v199, v199, v183
    v_cvt_pk_bf16_f32 v207, v198, v199
    v_mfma_f32_32x32x16_bf16 v[152:167], a[212:215], v[112:115], v[152:167]
    ds_read_b64_tr_b16 a[244:245], v14 offset:26624
    ds_read_b64_tr_b16 a[246:247], v14 offset:27136
    buffer_load_dwordx4 v8, s[32:35], s78 offen offset:0 lds
    s_lshl_b32 s54, s48, 6
    s_mul_i32 s55, s44, 56
    s_add_u32 s55, s55, 1
    v_mfma_f32_32x32x16_bf16 v[136:151], a[216:219], v[116:119], v[136:151]
    ds_read_b64_tr_b16 a[248:249], v12 offset:27648
    ds_read_b64_tr_b16 a[250:251], v12 offset:28160
    v_add_u32 v4, s54, v2
    v_lshl_add_u32 v216, v3, 2, s55
    v_cvt_f32_u32 v4, v4
    v_cvt_f32_u32 v216, v216
    v_mov_b32 v217, 0x3b124925
    v_mfma_f32_32x32x16_bf16 v[152:167], a[220:223], v[116:119], v[152:167]
    ds_read_b64_tr_b16 a[252:253], v14 offset:27648
    ds_read_b64_tr_b16 a[254:255], v14 offset:28160
    s_waitcnt lgkmcnt(8)
    buffer_load_dwordx4 v9, s[32:35], s78 offen offset:1024 lds
    v_add_f32 v5, 0x42000000, v4
    v_mul_f32 v6, v4, v216
    v_mfma_f32_32x32x16_bf16 v[136:151], a[224:227], v[120:123], v[136:151]
    ds_read_b64_tr_b16 a[208:209], v13 offset:0
    ds_read_b64_tr_b16 a[210:211], v13 offset:512
    buffer_store_dwordx4 v[200:203], v1, s[36:39], s59 offen sc1
    s_waitcnt vmcnt(11)
    ds_read_b64_tr_b16 a[120:121], v16 offset:6144
    ds_read_b64_tr_b16 a[122:123], v16 offset:7168
    v_mfma_f32_32x32x16_bf16 v[152:167], a[228:231], v[120:123], v[152:167]
    ds_read_b64_tr_b16 a[212:213], v15 offset:0
    ds_read_b64_tr_b16 a[214:215], v15 offset:512
    ds_read_b64_tr_b16 a[124:125], v17 offset:6144
    ds_read_b64_tr_b16 a[126:127], v17 offset:7168
    v_fmaak_f32 v214, v6, v217, 0x3a924925
    v_floor_f32 v214, v214
    v_fmamk_f32 v6, v214, 0xc3e00000, v6
    v_mfma_f32_32x32x16_bf16 v[136:151], a[232:235], v[124:127], v[136:151]
    ds_read_b64_tr_b16 a[216:217], v13 offset:1024
    ds_read_b64_tr_b16 a[218:219], v13 offset:1536
    buffer_store_dwordx4 v[204:207], v21, s[36:39], s59 offen sc1
    v_mfma_f32_32x32x16_bf16 v[152:167], a[236:239], v[124:127], v[152:167]
    ds_read_b64_tr_b16 a[220:221], v15 offset:1024
    ds_read_b64_tr_b16 a[222:223], v15 offset:1536
    s_waitcnt lgkmcnt(12)
    s_add_u32 s59, s59, 28672
    v_mul_f32 v6, v6, v217
    v_mul_f32 v4, v4, v217
    v_mul_f32 v214, 0x41000000, v4
    v_mfma_f32_32x32x16_bf16 v[136:151], a[240:243], v[128:131], v[136:151]
    ds_read_b64_tr_b16 a[224:225], v13 offset:2048
    ds_read_b64_tr_b16 a[226:227], v13 offset:2560
    s_waitcnt lgkmcnt(6)
    s_add_u32 m0, s61, 6144
    s_add_u32 s32, s32, 28672
    s_addc_u32 s33, s33, 0
    s_mov_b32 s34, 1519616
    s_waitcnt vmcnt(10)
    ds_read_b64_tr_b16 a[128:129], v16 offset:8192
    ds_read_b64_tr_b16 a[130:131], v16 offset:9216
    v_mfma_f32_32x32x16_bf16 v[152:167], a[244:247], v[128:131], v[152:167]
L_padg3:
    s_cbranch_execz L_backg
    ds_read_b64_tr_b16 a[228:229], v15 offset:2048
    ds_read_b64_tr_b16 a[230:231], v15 offset:2560
    buffer_load_dwordx4 v8, s[32:35], s72 offen offset:0 lds
    ds_read_b64_tr_b16 a[132:133], v17 offset:8192
    ds_read_b64_tr_b16 a[134:135], v17 offset:9216
    v_mul_f32 v7, v5, v216
    v_mfma_f32_32x32x16_bf16 v[136:151], a[248:251], v[132:135], v[136:151]
    ds_read_b64_tr_b16 a[232:233], v13 offset:3072
    ds_read_b64_tr_b16 a[234:235], v13 offset:3584
    v_cos_f32 v214, v214
    v_fmaak_f32 v215, v7, v217, 0x3a924925
    v_floor_f32 v215, v215
    v_fmamk_f32 v7, v215, 0xc3e00000, v7
    v_mfma_f32_32x32x16_bf16 v[152:167], a[252:255], v[132:135], v[152:167]
    ds_read_b64_tr_b16 a[236:237], v15 offset:3072
    ds_read_b64_tr_b16 a[238:239], v15 offset:3584
    s_waitcnt lgkmcnt(12)
    buffer_load_dwordx4 v9, s[32:35], s72 offen offset:1024 lds
    v_mul_f32 v7, v7, v217
    v_mul_f32 v5, v5, v217
    v_mfma_f32_32x32x16_bf16 v[168:183], a[208:211], v[24:27], 0
    ds_read_b64_tr_b16 a[240:241], v13 offset:4096
    ds_read_b64_tr_b16 a[242:243], v13 offset:4608
    s_waitcnt lgkmcnt(6)
    s_add_u32 m0, s61, 8192
    s_waitcnt vmcnt(10)
    ds_read_b64_tr_b16 a[136:137], v16 offset:10240
    ds_read_b64_tr_b16 a[138:139], v16 offset:11264
    v_mfma_f32_32x32x16_bf16 v[184:199], a[212:215], v[24:27], 0
    ds_read_b64_tr_b16 a[244:245], v15 offset:4096
    ds_read_b64_tr_b16 a[246:247], v15 offset:4608
    buffer_load_dwordx4 v8, s[32:35], s73 offen offset:0 lds
    ds_read_b64_tr_b16 a[140:141], v17 offset:10240
    ds_read_b64_tr_b16 a[142:143], v17 offset:11264
    v_mul_f32 v215, 0x41000000, v5
    v_mfma_f32_32x32x16_bf16 v[168:183], a[216:219], v[28:31], v[168:183]
    ds_read_b64_tr_b16 a[248:249], v13 offset:5120
    ds_read_b64_tr_b16 a[250:251], v13 offset:5632
    v_mul_f32 v152, v136, v152
    v_mul_f32 v153, v137, v153
    v_exp_f32 v136, -v136
    v_mul_f32 v154, v138, v154
    v_mfma_f32_32x32x16_bf16 v[184:199], a[220:223], v[28:31], v[184:199]
    ds_read_b64_tr_b16 a[252:253], v15 offset:5120
    ds_read_b64_tr_b16 a[254:255], v15 offset:5632
    s_waitcnt lgkmcnt(12)
    buffer_load_dwordx4 v9, s[32:35], s73 offen offset:1024 lds
    v_exp_f32 v137, -v137
    v_mfma_f32_32x32x16_bf16 v[168:183], a[224:227], v[32:35], v[168:183]
    ds_read_b64_tr_b16 a[208:209], v13 offset:6144
    ds_read_b64_tr_b16 a[210:211], v13 offset:6656
    s_waitcnt lgkmcnt(6)
    s_add_u32 m0, s61, 10240
    v_fma_f32 v136, v136, v18, v18
    v_fma_f32 v137, v137, v18, v18
    v_mul_f32 v155, v139, v155
    v_mfma_f32_32x32x16_bf16 v[184:199], a[228:231], v[32:35], v[184:199]
    ds_read_b64_tr_b16 a[212:213], v15 offset:6144
    ds_read_b64_tr_b16 a[214:215], v15 offset:6656
    buffer_load_dwordx4 v8, s[32:35], s74 offen offset:0 lds
    s_waitcnt vmcnt(11)
    ds_read_b64_tr_b16 a[144:145], v16 offset:0
    ds_read_b64_tr_b16 a[146:147], v16 offset:1024
    v_mfma_f32_32x32x16_bf16 v[168:183], a[232:235], v[36:39], v[168:183]
    ds_read_b64_tr_b16 a[216:217], v13 offset:7168
    ds_read_b64_tr_b16 a[218:219], v13 offset:7680
    ds_read_b64_tr_b16 a[148:149], v17 offset:0
    ds_read_b64_tr_b16 a[150:151], v17 offset:1024
    v_rcp_f32 v136, v136
    v_mul_f32 v156, v140, v156
    v_mfma_f32_32x32x16_bf16 v[184:199], a[236:239], v[36:39], v[184:199]
    ds_read_b64_tr_b16 a[220:221], v15 offset:7168
    ds_read_b64_tr_b16 a[222:223], v15 offset:7680
    s_waitcnt lgkmcnt(12)
    buffer_load_dwordx4 v9, s[32:35], s74 offen offset:1024 lds
    v_mov_b32 v23, 0
    v_mul_f32 v152, v152, v136
    v_mfma_f32_32x32x16_bf16 v[168:183], a[240:243], v[40:43], v[168:183]
    ds_read_b64_tr_b16 a[224:225], v13 offset:8192
    ds_read_b64_tr_b16 a[226:227], v13 offset:8704
    buffer_atomic_or v23, v22, s[36:39], s58 offen offset:0 sc0 sc1
    v_rcp_f32 v137, v137
    v_mfma_f32_32x32x16_bf16 v[184:199], a[244:247], v[40:43], v[184:199]
    ds_read_b64_tr_b16 a[228:229], v15 offset:8192
    ds_read_b64_tr_b16 a[230:231], v15 offset:8704
    s_waitcnt lgkmcnt(6)
    s_add_u32 m0, s61, 0
    s_waitcnt vmcnt(11)
    ds_read_b64_tr_b16 a[152:153], v16 offset:2048
    ds_read_b64_tr_b16 a[154:155], v16 offset:3072
    v_mfma_f32_32x32x16_bf16 v[168:183], a[248:251], v[44:47], v[168:183]
    ds_read_b64_tr_b16 a[232:233], v13 offset:9216
    ds_read_b64_tr_b16 a[234:235], v13 offset:9728
    buffer_load_dwordx4 v8, s[32:35], s75 offen offset:0 lds
    ds_read_b64_tr_b16 a[156:157], v17 offset:2048
    ds_read_b64_tr_b16 a[158:159], v17 offset:3072
    v_mul_f32 v153, v153, v137
    v_mfma_f32_32x32x16_bf16 v[184:199], a[252:255], v[44:47], v[184:199]
    ds_read_b64_tr_b16 a[236:237], v15 offset:9216
    ds_read_b64_tr_b16 a[238:239], v15 offset:9728
    s_waitcnt lgkmcnt(12)
    v_cvt_pk_bf16_f32 v200, v152, v153
    v_exp_f32 v138, -v138
    v_mul_f32 v157, v141, v157
    v_mfma_f32_32x32x16_bf16 v[168:183], a[208:211], v[48:51], v[168:183]
    ds_read_b64_tr_b16 a[240:241], v13 offset:10240
    ds_read_b64_tr_b16 a[242:243], v13 offset:10752
    buffer_load_dwordx4 v9, s[32:35], s75 offen offset:1024 lds
    v_exp_f32 v139, -v139
    v_fma_f32 v138, v138, v18, v18
    v_mfma_f32_32x32x16_bf16 v[184:199], a[212:215], v[48:51], v[184:199]
    ds_read_b64_tr_b16 a[244:245], v15 offset:10240
    ds_read_b64_tr_b16 a[246:247], v15 offset:10752
    s_waitcnt lgkmcnt(6)
    s_add_u32 m0, s61, 2048
    v_fma_f32 v139, v139, v18, v18
    v_rcp_f32 v138, v138
    v_mfma_f32_32x32x16_bf16 v[168:183], a[216:219], v[52:55], v[168:183]
    ds_read_b64_tr_b16 a[248:249], v13 offset:11264
    ds_read_b64_tr_b16 a[250:251], v13 offset:11776
    buffer_load_dwordx4 v8, s[32:35], s76 offen offset:0 lds
    s_waitcnt vmcnt(12)
    ds_read_b64_tr_b16 a[160:161], v16 offset:4096
    ds_read_b64_tr_b16 a[162:163], v16 offset:5120
    v_mfma_f32_32x32x16_bf16 v[184:199], a[220:223], v[52:55], v[184:199]
    ds_read_b64_tr_b16 a[252:253], v15 offset:11264
    ds_read_b64_tr_b16 a[254:255], v15 offset:11776
    s_waitcnt lgkmcnt(10)
    s_waitcnt vmcnt(10)
    buffer_atomic_swap v19, v20, s[36:39], s57 offen offset:128 sc1
    ds_read_b64_tr_b16 a[164:165], v17 offset:4096
    ds_read_b64_tr_b16 a[166:167], v17 offset:5120
    v_mfma_f32_32x32x16_bf16 v[168:183], a[224:227], v[56:59], v[168:183]
    ds_read_b64_tr_b16 a[208:209], v13 offset:12288
    ds_read_b64_tr_b16 a[210:211], v13 offset:12800
    v_rcp_f32 v139, v139
    v_mul_f32 v154, v154, v138
    v_mul_f32 v155, v155, v139
    v_cvt_pk_bf16_f32 v201, v154, v155
    v_mfma_f32_32x32x16_bf16 v[184:199], a[228:231], v[56:59], v[184:199]
    ds_read_b64_tr_b16 a[212:213], v15 offset:12288
    ds_read_b64_tr_b16 a[214:215], v15 offset:12800
    buffer_load_dwordx4 v9, s[32:35], s76 offen offset:1024 lds
    v_exp_f32 v140, -v140
    v_mul_f32 v158, v142, v158
    v_mfma_f32_32x32x16_bf16 v[168:183], a[232:235], v[60:63], v[168:183]
    ds_read_b64_tr_b16 a[216:217], v13 offset:13312
    ds_read_b64_tr_b16 a[218:219], v13 offset:13824
    s_waitcnt lgkmcnt(6)
    s_add_u32 m0, s61, 4096
    s_waitcnt vmcnt(10)
    ds_read_b64_tr_b16 a[168:169], v16 offset:6144
    ds_read_b64_tr_b16 a[170:171], v16 offset:7168
    v_mfma_f32_32x32x16_bf16 v[184:199], a[236:239], v[60:63], v[184:199]
    ds_read_b64_tr_b16 a[220:221], v15 offset:13312
    ds_read_b64_tr_b16 a[222:223], v15 offset:13824
    buffer_load_dwordx4 v8, s[32:35], s77 offen offset:0 lds
    ds_read_b64_tr_b16 a[172:173], v17 offset:6144
    ds_read_b64_tr_b16 a[174:175], v17 offset:7168
    v_mfma_f32_32x32x16_bf16 v[168:183], a[240:243], v[64:67], v[168:183]
    ds_read_b64_tr_b16 a[224:225], v13 offset:14336
    ds_read_b64_tr_b16 a[226:227], v13 offset:14848
    v_exp_f32 v141, -v141
    v_fma_f32 v140, v140, v18, v18
    v_fma_f32 v141, v141, v18, v18
    v_mul_f32 v159, v143, v159
    v_mfma_f32_32x32x16_bf16 v[184:199], a[244:247], v[64:67], v[184:199]
    ds_read_b64_tr_b16 a[228:229], v15 offset:14336
    ds_read_b64_tr_b16 a[230:231], v15 offset:14848
    buffer_load_dwordx4 v9, s[32:35], s77 offen offset:1024 lds
    v_rcp_f32 v140, v140
    v_mul_f32 v160, v144, v160
    v_mfma_f32_32x32x16_bf16 v[168:183], a[248:251], v[68:71], v[168:183]
    ds_read_b64_tr_b16 a[232:233], v13 offset:15360
    ds_read_b64_tr_b16 a[234:235], v13 offset:15872
    s_waitcnt lgkmcnt(6)
    s_add_u32 m0, s61, 6144
    v_rcp_f32 v141, v141
    v_mul_f32 v156, v156, v140
    v_mfma_f32_32x32x16_bf16 v[184:199], a[252:255], v[68:71], v[184:199]
    ds_read_b64_tr_b16 a[236:237], v15 offset:15360
    ds_read_b64_tr_b16 a[238:239], v15 offset:15872
    buffer_load_dwordx4 v8, s[32:35], s78 offen offset:0 lds
    v_mul_f32 v157, v157, v141
    v_cvt_pk_bf16_f32 v202, v156, v157
    v_mfma_f32_32x32x16_bf16 v[168:183], a[208:211], v[72:75], v[168:183]
    ds_read_b64_tr_b16 a[240:241], v13 offset:16384
    ds_read_b64_tr_b16 a[242:243], v13 offset:16896
    v_exp_f32 v142, -v142
    v_exp_f32 v143, -v143
    v_fma_f32 v142, v142, v18, v18
    v_mfma_f32_32x32x16_bf16 v[184:199], a[212:215], v[72:75], v[184:199]
    ds_read_b64_tr_b16 a[244:245], v15 offset:16384
    ds_read_b64_tr_b16 a[246:247], v15 offset:16896
    buffer_load_dwordx4 v9, s[32:35], s78 offen offset:1024 lds
    v_fma_f32 v143, v143, v18, v18
    v_rcp_f32 v142, v142
    v_mfma_f32_32x32x16_bf16 v[168:183], a[216:219], v[76:79], v[168:183]
    ds_read_b64_tr_b16 a[248:249], v13 offset:17408
    ds_read_b64_tr_b16 a[250:251], v13 offset:17920
    v_rcp_f32 v143, v143
    v_mul_f32 v158, v158, v142
    v_mul_f32 v159, v159, v143
    v_cvt_pk_bf16_f32 v203, v158, v159
    v_mfma_f32_32x32x16_bf16 v[184:199], a[220:223], v[76:79], v[184:199]
    ds_read_b64_tr_b16 a[252:253], v15 offset:17408
    ds_read_b64_tr_b16 a[254:255], v15 offset:17920
    s_waitcnt lgkmcnt(8)
    s_waitcnt vmcnt(9)
    v_cmp_ne_u32 vcc, v19, v23
    s_nop 0
    s_and_b32 vcc_lo, vcc_lo, 0x3fff
    s_cbranch_scc1 L_pl1
L_pd1:
    v_mfma_f32_32x32x16_bf16 v[168:183], a[224:227], v[80:83], v[168:183]
    ds_read_b64_tr_b16 a[208:209], v13 offset:18432
    ds_read_b64_tr_b16 a[210:211], v13 offset:18944
    v_mul_f32 v161, v145, v161
    v_exp_f32 v144, -v144
    v_exp_f32 v145, -v145
    v_mfma_f32_32x32x16_bf16 v[184:199], a[228:231], v[80:83], v[184:199]
    ds_read_b64_tr_b16 a[212:213], v15 offset:18432
    ds_read_b64_tr_b16 a[214:215], v15 offset:18944
    buffer_load_dwordx4 v[24:27], v208, s[36:39], 0 offen offset:0 sc1
    v_fma_f32 v144, v144, v18, v18
    v_fma_f32 v145, v145, v18, v18
    v_mul_f32 v162, v146, v162
    v_mfma_f32_32x32x16_bf16 v[168:183], a[232:235], v[84:87], v[168:183]
    ds_read_b64_tr_b16 a[216:217], v13 offset:19456
    ds_read_b64_tr_b16 a[218:219], v13 offset:19968
    v_rcp_f32 v144, v144
    v_rcp_f32 v145, v145
    v_mul_f32 v160, v160, v144
    v_mfma_f32_32x32x16_bf16 v[184:199], a[236:239], v[84:87], v[184:199]
    ds_read_b64_tr_b16 a[220:221], v15 offset:19456
    ds_read_b64_tr_b16 a[222:223], v15 offset:19968
    s_waitcnt lgkmcnt(8)
    buffer_load_dwordx4 v[28:31], v209, s[36:39], 0 offen offset:0 sc1
    v_mul_f32 v161, v161, v145
    v_cvt_pk_bf16_f32 v204, v160, v161
    v_mfma_f32_32x32x16_bf16 v[168:183], a[240:243], v[88:91], v[168:183]
    ds_read_b64_tr_b16 a[224:225], v13 offset:20480
    ds_read_b64_tr_b16 a[226:227], v13 offset:20992
    v_mul_f32 v163, v147, v163
    v_exp_f32 v146, -v146
    v_exp_f32 v147, -v147
    v_mfma_f32_32x32x16_bf16 v[184:199], a[244:247], v[88:91], v[184:199]
    ds_read_b64_tr_b16 a[228:229], v15 offset:20480
    ds_read_b64_tr_b16 a[230:231], v15 offset:20992
    buffer_load_dwordx4 v[32:35], v208, s[36:39], 0 offen offset:1024 sc1
    v_fma_f32 v146, v146, v18, v18
    v_fma_f32 v147, v147, v18, v18
    v_mul_f32 v164, v148, v164
    v_mfma_f32_32x32x16_bf16 v[168:183], a[248:251], v[92:95], v[168:183]
    ds_read_b64_tr_b16 a[232:233], v13 offset:21504
    ds_read_b64_tr_b16 a[234:235], v13 offset:22016
    v_rcp_f32 v146, v146
    v_rcp_f32 v147, v147
    v_mul_f32 v162, v162, v146
    v_mfma_f32_32x32x16_bf16 v[184:199], a[252:255], v[92:95], v[184:199]
    ds_read_b64_tr_b16 a[236:237], v15 offset:21504
    ds_read_b64_tr_b16 a[238:239], v15 offset:22016
    s_waitcnt lgkmcnt(8)
    buffer_load_dwordx4 v[36:39], v209, s[36:39], 0 offen offset:1024 sc1
    v_mul_f32 v163, v163, v147
    v_cvt_pk_bf16_f32 v205, v162, v163
    v_mfma_f32_32x32x16_bf16 v[168:183], a[208:211], v[96:99], v[168:183]
    ds_read_b64_tr_b16 a[240:241], v13 offset:22528
    ds_read_b64_tr_b16 a[242:243], v13 offset:23040
    buffer_load_dwordx4 v[40:43], v208, s[36:39], 0 offen offset:2048 sc1
    v_mov_b32 v23, 0
    v_mul_f32 v165, v149, v165
    v_mul_f32 v166, v150, v166
    v_mfma_f32_32x32x16_bf16 v[184:199], a[212:215], v[96:99], v[184:199]
    ds_read_b64_tr_b16 a[244:245], v15 offset:22528
    ds_read_b64_tr_b16 a[246:247], v15 offset:23040
    buffer_atomic_or v23, v22, s[36:39], s58 offen offset:128 sc0 sc1
    v_exp_f32 v148, -v148
    v_exp_f32 v149, -v149
    v_fma_f32 v148, v148, v18, v18
    v_fma_f32 v149, v149, v18, v18
    v_rcp_f32 v148, v148
    v_rcp_f32 v149, v149
    v_mul_f32 v164, v164, v148
    v_mul_f32 v165, v165, v149
    v_cvt_pk_bf16_f32 v206, v164, v165
    v_mul_f32 v167, v151, v167
    v_exp_f32 v150, -v150
    v_exp_f32 v151, -v151
    v_fma_f32 v150, v150, v18, v18
    v_fma_f32 v151, v151, v18, v18
    v_rcp_f32 v150, v150
    v_rcp_f32 v151, v151
    v_mul_f32 v166, v166, v150
    v_mul_f32 v167, v167, v151
    v_cvt_pk_bf16_f32 v207, v166, v167
    v_mfma_f32_32x32x16_bf16 v[168:183], a[216:219], v[100:103], v[168:183]
    ds_read_b64_tr_b16 a[248:249], v13 offset:23552
    ds_read_b64_tr_b16 a[250:251], v13 offset:24064
    buffer_store_dwordx4 v[200:203], v1, s[36:39], s59 offen sc1
    v_mfma_f32_32x32x16_bf16 v[184:199], a[220:223], v[100:103], v[184:199]
    ds_read_b64_tr_b16 a[252:253], v15 offset:23552
    ds_read_b64_tr_b16 a[254:255], v15 offset:24064
    s_waitcnt lgkmcnt(8)
    v_cos_f32 v215, v215
    v_add_f32 v214, v214, v214
    v_add_f32 v215, v215, v215
    v_mfma_f32_32x32x16_bf16 v[168:183], a[224:227], v[104:107], v[168:183]
    ds_read_b64_tr_b16 a[208:209], v13 offset:24576
    ds_read_b64_tr_b16 a[210:211], v13 offset:25088
    buffer_store_dwordx4 v[204:207], v21, s[36:39], s59 offen sc1
    v_mfma_f32_32x32x16_bf16 v[184:199], a[228:231], v[104:107], v[184:199]
    ds_read_b64_tr_b16 a[212:213], v15 offset:24576
    ds_read_b64_tr_b16 a[214:215], v15 offset:25088
    s_add_u32 s59, s59, 28672
    v_mfma_f32_32x32x16_bf16 v[168:183], a[232:235], v[108:111], v[168:183]
    ds_read_b64_tr_b16 a[216:217], v13 offset:25600
    ds_read_b64_tr_b16 a[218:219], v13 offset:26112
    v_mfma_f32_32x32x16_bf16 v[184:199], a[236:239], v[108:111], v[184:199]
    ds_read_b64_tr_b16 a[220:221], v15 offset:25600
    ds_read_b64_tr_b16 a[222:223], v15 offset:26112
    s_waitcnt lgkmcnt(8)
    v_mfma_f32_32x32x16_bf16 v[168:183], a[240:243], v[112:115], v[168:183]
    ds_read_b64_tr_b16 a[224:225], v13 offset:26624
    ds_read_b64_tr_b16 a[226:227], v13 offset:27136
    buffer_load_dwordx4 v[44:47], v209, s[36:39], 0 offen offset:2048 sc1
    v_mfma_f32_32x32x16_bf16 v[184:199], a[244:247], v[112:115], v[184:199]
    ds_read_b64_tr_b16 a[228:229], v15 offset:26624
    ds_read_b64_tr_b16 a[230:231], v15 offset:27136
    v_mfma_f32_32x32x16_bf16 v[168:183], a[248:251], v[116:119], v[168:183]
    ds_read_b64_tr_b16 a[232:233], v13 offset:27648
    ds_read_b64_tr_b16 a[234:235], v13 offset:28160
    buffer_load_dwordx4 v[48:51], v208, s[36:39], 0 offen offset:3072 sc1
    v_mfma_f32_32x32x16_bf16 v[184:199], a[252:255], v[116:119], v[184:199]
    ds_read_b64_tr_b16 a[236:237], v15 offset:27648
    ds_read_b64_tr_b16 a[238:239], v15 offset:28160
    s_waitcnt lgkmcnt(8)
    v_mfma_f32_32x32x16_bf16 v[168:183], a[208:211], v[120:123], v[168:183]
    buffer_load_dwordx4 v[52:55], v209, s[36:39], 0 offen offset:3072 sc1
    s_lshl2_add_u32 s62, s47, s44
    s_lshl_b32 s62, s62, 7
    s_add_u32 s62, s62, 65536
    v_mfma_f32_32x32x16_bf16 v[184:199], a[212:215], v[120:123], v[184:199]
    v_add_u32 v13, 36, v0
    v_and_b32 v13, 64, v13
    v_mfma_f32_32x32x16_bf16 v[168:183], a[216:219], v[124:127], v[168:183]
    buffer_load_dwordx4 v[56:59], v208, s[36:39], s65 offen offset:0 sc1
    v_lshlrev_b32 v12, 2, v0
    v_lshl_add_u32 v12, v13, 24, v12
    v_mfma_f32_32x32x16_bf16 v[184:199], a[220:223], v[124:127], v[184:199]
    s_waitcnt lgkmcnt(0)
    v_mfma_f32_32x32x16_bf16 v[168:183], a[224:227], v[128:131], v[168:183]
    buffer_load_dwordx4 v[60:63], v209, s[36:39], s65 offen offset:0 sc1
    v_mfma_f32_32x32x16_bf16 v[184:199], a[228:231], v[128:131], v[184:199]
    v_mfma_f32_32x32x16_bf16 v[168:183], a[232:235], v[132:135], v[168:183]
    buffer_load_dwordx4 v[64:67], v208, s[36:39], s65 offen offset:1024 sc1
    v_mfma_f32_32x32x16_bf16 v[184:199], a[236:239], v[132:135], v[184:199]
    s_waitcnt vmcnt(12)
    v_mfma_f32_32x32x16_bf16 v[136:151], a[0:3], v[24:27], 0
    buffer_load_dwordx4 v[68:71], v209, s[36:39], s65 offen offset:1024 sc1
    v_mfma_f32_32x32x16_bf16 v[152:167], a[4:7], v[24:27], 0
    s_waitcnt vmcnt(9)
    v_cmp_ne_u32 vcc, v19, v23
    s_nop 0
    s_and_b32 vcc_lo, vcc_lo, 0x3fff
    s_cbranch_scc1 L_pl2
L_pd2:
    v_mfma_f32_32x32x16_bf16 v[224:239], a[0:3], v[28:31], 0
    buffer_load_dwordx4 v[72:75], v208, s[36:39], s65 offen offset:2048 sc1
    s_nop 0
    v_mul_f32 v184, v168, v184
    v_mul_f32 v185, v169, v185
    v_exp_f32 v168, -v168
    v_mul_f32 v186, v170, v186
    v_mfma_f32_32x32x16_bf16 v[240:255], a[4:7], v[28:31], 0
    buffer_load_dwordx4 v[76:79], v209, s[36:39], s65 offen offset:2048 sc1
    v_exp_f32 v169, -v169
    v_fma_f32 v168, v168, v18, v18
    v_fma_f32 v169, v169, v18, v18
    v_mfma_f32_32x32x16_bf16 v[136:151], a[8:11], v[32:35], v[136:151]
    v_add_u32 v208, 28672, v208
    v_add_u32 v209, 28672, v209
    v_rcp_f32 v168, v168
    v_rcp_f32 v169, v169
    v_mul_f32 v184, v184, v168
    v_mfma_f32_32x32x16_bf16 v[152:167], a[12:15], v[32:35], v[152:167]
    s_waitcnt vmcnt(9)
    buffer_atomic_swap v19, v20, s[36:39], s57 offen offset:256 sc1
    v_mul_f32 v185, v185, v169
    v_cvt_pk_bf16_f32 v200, v184, v185
    v_mul_f32 v187, v171, v187
    v_mfma_f32_32x32x16_bf16 v[224:239], a[8:11], v[36:39], v[224:239]
    buffer_load_dwordx4 v[80:83], v208, s[36:39], 0 offen offset:0 sc1
    v_exp_f32 v170, -v170
    v_exp_f32 v171, -v171
    v_fma_f32 v170, v170, v18, v18
    v_mfma_f32_32x32x16_bf16 v[240:255], a[12:15], v[36:39], v[240:255]
    s_waitcnt vmcnt(10)
    v_fma_f32 v171, v171, v18, v18
    v_rcp_f32 v170, v170
    v_rcp_f32 v171, v171
    v_mul_f32 v186, v186, v170
    v_mfma_f32_32x32x16_bf16 v[136:151], a[16:19], v[40:43], v[136:151]
    buffer_load_dwordx4 v[84:87], v209, s[36:39], 0 offen offset:0 sc1
    v_mul_f32 v187, v187, v171
    v_cvt_pk_bf16_f32 v201, v186, v187
    v_mul_f32 v188, v172, v188
    v_mul_f32 v189, v173, v189
    v_mul_f32 v190, v174, v190
    v_mfma_f32_32x32x16_bf16 v[152:167], a[20:23], v[40:43], v[152:167]
    v_exp_f32 v172, -v172
    v_exp_f32 v173, -v173
    v_fma_f32 v172, v172, v18, v18
    v_fma_f32 v173, v173, v18, v18
    v_mul_f32 v191, v175, v191
    v_mfma_f32_32x32x16_bf16 v[224:239], a[16:19], v[44:47], v[224:239]
    buffer_load_dwordx4 v[88:91], v208, s[36:39], 0 offen offset:1024 sc1
    v_rcp_f32 v172, v172
    v_rcp_f32 v173, v173
    v_mul_f32 v188, v188, v172
    v_mfma_f32_32x32x16_bf16 v[240:255], a[20:23], v[44:47], v[240:255]
    s_waitcnt vmcnt(10)
    v_mul_f32 v189, v189, v173
    v_cvt_pk_bf16_f32 v202, v188, v189
    v_exp_f32 v174, -v174
    v_exp_f32 v175, -v175
    v_mfma_f32_32x32x16_bf16 v[136:151], a[24:27], v[48:51], v[136:151]
    buffer_load_dwordx4 v[92:95], v209, s[36:39], 0 offen offset:1024 sc1
    v_fma_f32 v174, v174, v18, v18
    v_fma_f32 v175, v175, v18, v18
    v_rcp_f32 v174, v174
    v_mul_f32 v192, v176, v192
    v_mfma_f32_32x32x16_bf16 v[152:167], a[28:31], v[48:51], v[152:167]
    v_rcp_f32 v175, v175
    v_mul_f32 v190, v190, v174
    v_mul_f32 v191, v191, v175
    v_cvt_pk_bf16_f32 v203, v190, v191
    v_mul_f32 v193, v177, v193
    v_mul_f32 v194, v178, v194
    v_mfma_f32_32x32x16_bf16 v[224:239], a[24:27], v[52:55], v[224:239]
    buffer_load_dwordx4 v[96:99], v208, s[36:39], 0 offen offset:2048 sc1
    v_exp_f32 v176, -v176
    v_exp_f32 v177, -v177
    v_fma_f32 v176, v176, v18, v18
    v_mfma_f32_32x32x16_bf16 v[240:255], a[28:31], v[52:55], v[240:255]
    buffer_load_dwordx4 v[100:103], v209, s[36:39], 0 offen offset:2048 sc1
    s_waitcnt vmcnt(11)
    v_fma_f32 v177, v177, v18, v18
    v_rcp_f32 v176, v176
    v_mul_f32 v195, v179, v195
    v_mfma_f32_32x32x16_bf16 v[136:151], a[32:35], v[56:59], v[136:151]
    v_rcp_f32 v177, v177
    v_mul_f32 v192, v192, v176
    v_mul_f32 v193, v193, v177
    v_cvt_pk_bf16_f32 v204, v192, v193
    v_exp_f32 v178, -v178
    v_mfma_f32_32x32x16_bf16 v[152:167], a[36:39], v[56:59], v[152:167]
    buffer_load_dwordx4 v[104:107], v208, s[36:39], 0 offen offset:3072 sc1
    v_exp_f32 v179, -v179
    v_fma_f32 v178, v178, v18, v18
    v_fma_f32 v179, v179, v18, v18
    v_mul_f32 v196, v180, v196
    v_mfma_f32_32x32x16_bf16 v[224:239], a[32:35], v[60:63], v[224:239]
    v_mov_b32 v23, 0
    v_rcp_f32 v178, v178
    v_rcp_f32 v179, v179
    v_mul_f32 v194, v194, v178
    v_mul_f32 v195, v195, v179
    v_mfma_f32_32x32x16_bf16 v[240:255], a[36:39], v[60:63], v[240:255]
    buffer_atomic_or v23, v22, s[36:39], s58 offen offset:256 sc0 sc1
    s_waitcnt vmcnt(11)
    v_cvt_pk_bf16_f32 v205, v194, v195
    v_mul_f32 v197, v181, v197
    v_mul_f32 v198, v182, v198
    v_exp_f32 v180, -v180
    v_exp_f32 v181, -v181
    v_fma_f32 v180, v180, v18, v18
    v_fma_f32 v181, v181, v18, v18
    v_rcp_f32 v180, v180
    v_rcp_f32 v181, v181
    v_mul_f32 v196, v196, v180
    v_mul_f32 v197, v197, v181
    v_cvt_pk_bf16_f32 v206, v196, v197
    v_mul_f32 v199, v183, v199
    v_exp_f32 v182, -v182
    v_exp_f32 v183, -v183
    v_fma_f32 v182, v182, v18, v18
    v_fma_f32 v183, v183, v18, v18
    v_rcp_f32 v182, v182
    v_rcp_f32 v183, v183
    v_mul_f32 v198, v198, v182
    v_mul_f32 v199, v199, v183
    v_cvt_pk_bf16_f32 v207, v198, v199
    v_mfma_f32_32x32x16_bf16 v[136:151], a[40:43], v[64:67], v[136:151]
    buffer_store_dwordx4 v[200:203], v1, s[36:39], s59 offen sc1
    v_fmamk_f32 v168, v4, 0x00000000, v6
    v_mfma_f32_32x32x16_bf16 v[152:167], a[44:47], v[64:67], v[152:167]
    v_sin_f32 v172, v168
    v_cos_f32 v168, v168
    v_fmamk_f32 v169, v4, 0x3f800000, v6
    v_sin_f32 v173, v169
    v_mfma_f32_32x32x16_bf16 v[224:239], a[40:43], v[68:71], v[224:239]
    buffer_store_dwordx4 v[204:207], v21, s[36:39], s59 offen sc1
    v_fmamk_f32 v170, v4, 0x40000000, v6
    v_mfma_f32_32x32x16_bf16 v[240:255], a[44:47], v[68:71], v[240:255]
    s_add_u32 s59, s59, 28672
    s_waitcnt vmcnt(11)
    v_cos_f32 v169, v169
    v_sin_f32 v174, v170
    v_fmamk_f32 v171, v4, 0x40400000, v6
    v_mfma_f32_32x32x16_bf16 v[136:151], a[48:51], v[72:75], v[136:151]
    v_cos_f32 v170, v170
    v_sin_f32 v175, v171
    v_cos_f32 v171, v171
    v_cvt_pk_bf16_f32 v24, v168, -v172
    v_mfma_f32_32x32x16_bf16 v[152:167], a[52:55], v[72:75], v[152:167]
    buffer_load_dwordx4 v[108:111], v209, s[36:39], 0 offen offset:3072 sc1
    v_cvt_pk_bf16_f32 v25, v169, -v173
    v_cvt_pk_bf16_f32 v26, v170, -v174
    v_cvt_pk_bf16_f32 v27, v171, -v175
    v_fmamk_f32 v184, v5, 0x00000000, v7
    v_fmamk_f32 v185, v5, 0x3f800000, v7
    v_mfma_f32_32x32x16_bf16 v[224:239], a[48:51], v[76:79], v[224:239]
    v_sin_f32 v188, v184
    v_cos_f32 v184, v184
    v_sin_f32 v189, v185
    v_fmamk_f32 v186, v5, 0x40000000, v7
    v_mfma_f32_32x32x16_bf16 v[240:255], a[52:55], v[76:79], v[240:255]
    buffer_load_dwordx4 v[112:115], v208, s[36:39], s65 offen offset:0 sc1
    s_waitcnt vmcnt(10)
    v_cos_f32 v185, v185
    v_fmamk_f32 v187, v5, 0x40400000, v7
    v_mfma_f32_32x32x16_bf16 v[136:151], a[56:59], v[80:83], v[136:151]
    v_sin_f32 v190, v186
    v_cos_f32 v186, v186
    v_sin_f32 v191, v187
    v_cvt_pk_bf16_f32 v28, v184, -v188
    v_mfma_f32_32x32x16_bf16 v[152:167], a[60:63], v[80:83], v[152:167]
    buffer_load_dwordx4 v[116:119], v209, s[36:39], s65 offen offset:0 sc1
    v_cos_f32 v187, v187
    v_cvt_pk_bf16_f32 v29, v185, -v189
    v_cvt_pk_bf16_f32 v30, v186, -v190
    v_cvt_pk_bf16_f32 v31, v187, -v191
    v_mfma_f32_32x32x16_bf16 v[224:239], a[56:59], v[84:87], v[224:239]
    v_fmamk_f32 v176, v4, 0x41000000, v6
    v_sin_f32 v180, v176
    v_cos_f32 v176, v176
    v_fmamk_f32 v177, v4, 0x41100000, v6
    v_fmamk_f32 v178, v4, 0x41200000, v6
    v_mfma_f32_32x32x16_bf16 v[240:255], a[60:63], v[84:87], v[240:255]
    buffer_load_dwordx4 v[120:123], v208, s[36:39], s65 offen offset:1024 sc1
    s_waitcnt vmcnt(10)
    v_sin_f32 v181, v177
    v_cos_f32 v177, v177
    v_mfma_f32_32x32x16_bf16 v[136:151], a[64:67], v[88:91], v[136:151]
    buffer_load_dwordx4 v[124:127], v209, s[36:39], s65 offen offset:1024 sc1
    v_sin_f32 v182, v178
    v_cos_f32 v178, v178
    v_fmamk_f32 v179, v4, 0x41300000, v6
    v_mfma_f32_32x32x16_bf16 v[152:167], a[68:71], v[88:91], v[152:167]
    s_waitcnt vmcnt(7)
    v_cmp_ne_u32 vcc, v19, v23
    s_nop 0
    s_and_b32 vcc_lo, vcc_lo, 0x3fff
    s_cbranch_scc1 L_pl3
L_pd3:
    v_mfma_f32_32x32x16_bf16 v[224:239], a[64:67], v[92:95], v[224:239]
    buffer_load_dwordx4 v[128:131], v208, s[36:39], s65 offen offset:2048 sc1
    v_sin_f32 v183, v179
    v_cos_f32 v179, v179
    v_cvt_pk_bf16_f32 v32, v176, -v180
    v_mfma_f32_32x32x16_bf16 v[240:255], a[68:71], v[92:95], v[240:255]
    v_cvt_pk_bf16_f32 v33, v177, -v181
    v_cvt_pk_bf16_f32 v34, v178, -v182
    v_cvt_pk_bf16_f32 v35, v179, -v183
    v_fmamk_f32 v192, v5, 0x41000000, v7
    v_sin_f32 v196, v192
    v_mfma_f32_32x32x16_bf16 v[136:151], a[72:75], v[96:99], v[136:151]
    buffer_load_dwordx4 v[132:135], v209, s[36:39], s65 offen offset:2048 sc1
    v_cos_f32 v192, v192
    v_fmamk_f32 v193, v5, 0x41100000, v7
    v_sin_f32 v197, v193
    v_mfma_f32_32x32x16_bf16 v[152:167], a[76:79], v[96:99], v[152:167]
    v_add_u32 v208, 28672, v208
    v_add_u32 v209, 28672, v209
    v_cos_f32 v193, v193
    v_fmamk_f32 v194, v5, 0x41200000, v7
    v_sin_f32 v198, v194
    v_mfma_f32_32x32x16_bf16 v[224:239], a[72:75], v[100:103], v[224:239]
    buffer_load_dwordx4 a[176:179], v208, s[36:39], 0 offen offset:0 sc1
    v_cos_f32 v194, v194
    v_fmamk_f32 v195, v5, 0x41300000, v7
    v_sin_f32 v199, v195
    v_mfma_f32_32x32x16_bf16 v[240:255], a[76:79], v[100:103], v[240:255]
    s_waitcnt vmcnt(7)
    v_cos_f32 v195, v195
    v_cvt_pk_bf16_f32 v36, v192, -v196
    v_cvt_pk_bf16_f32 v37, v193, -v197
    v_cvt_pk_bf16_f32 v38, v194, -v198
    v_cvt_pk_bf16_f32 v39, v195, -v199
    v_mfma_f32_32x32x16_bf16 v[136:151], a[80:83], v[104:107], v[136:151]
    buffer_load_dwordx4 a[180:183], v209, s[36:39], 0 offen offset:0 sc1
    v_fma_f32 v168, v214, v176, -v168
    v_fma_f32 v172, v214, v180, -v172
    v_fma_f32 v169, v214, v177, -v169
    v_fma_f32 v173, v214, v181, -v173
    v_fma_f32 v170, v214, v178, -v170
    v_mfma_f32_32x32x16_bf16 v[152:167], a[84:87], v[104:107], v[152:167]
    buffer_load_dwordx4 a[184:187], v208, s[36:39], 0 offen offset:1024 sc1
    v_mov_b32 v14, 0
    v_fma_f32 v174, v214, v182, -v174
    v_fma_f32 v171, v214, v179, -v171
    v_fma_f32 v175, v214, v183, -v175
    v_cvt_pk_bf16_f32 v40, v168, -v172
    v_mfma_f32_32x32x16_bf16 v[224:239], a[80:83], v[108:111], v[224:239]
L_padg4:
    s_cbranch_execz L_backg
    buffer_atomic_or v14, v12, s[36:39], s62 offen offset:0 sc0 sc1
    v_cvt_pk_bf16_f32 v41, v169, -v173
    v_cvt_pk_bf16_f32 v42, v170, -v174
    v_cvt_pk_bf16_f32 v43, v171, -v175
    v_fma_f32 v184, v215, v192, -v184
    v_mfma_f32_32x32x16_bf16 v[240:255], a[84:87], v[108:111], v[240:255]
    buffer_atomic_swap v19, v20, s[36:39], s57 offen offset:384 sc1
    s_waitcnt vmcnt(9)
    v_fma_f32 v188, v215, v196, -v188
    v_fma_f32 v185, v215, v193, -v185
    v_mfma_f32_32x32x16_bf16 v[136:151], a[88:91], v[112:115], v[136:151]
    v_fma_f32 v189, v215, v197, -v189
    v_fma_f32 v186, v215, v194, -v186
    v_fma_f32 v190, v215, v198, -v190
    v_fma_f32 v187, v215, v195, -v187
    v_fma_f32 v191, v215, v199, -v191
    v_cvt_pk_bf16_f32 v44, v184, -v188
    v_cvt_pk_bf16_f32 v45, v185, -v189
    v_mfma_f32_32x32x16_bf16 v[152:167], a[92:95], v[112:115], v[152:167]
    buffer_load_dwordx4 a[188:191], v209, s[36:39], 0 offen offset:1024 sc1
    v_cvt_pk_bf16_f32 v46, v186, -v190
    v_cvt_pk_bf16_f32 v47, v187, -v191
    v_fma_f32 v176, v214, v168, -v176
    v_fma_f32 v180, v214, v172, -v180
    v_fma_f32 v177, v214, v169, -v177
    v_mfma_f32_32x32x16_bf16 v[224:239], a[88:91], v[116:119], v[224:239]
    v_fma_f32 v181, v214, v173, -v181
    v_fma_f32 v178, v214, v170, -v178
    v_fma_f32 v182, v214, v174, -v182
    v_fma_f32 v179, v214, v171, -v179
    v_fma_f32 v183, v214, v175, -v183
    v_cvt_pk_bf16_f32 v48, v176, -v180
    v_cvt_pk_bf16_f32 v49, v177, -v181
    v_mfma_f32_32x32x16_bf16 v[240:255], a[92:95], v[116:119], v[240:255]
    buffer_load_dwordx4 a[192:195], v208, s[36:39], 0 offen offset:2048 sc1
    s_waitcnt vmcnt(9)
    v_cvt_pk_bf16_f32 v50, v178, -v182
    v_cvt_pk_bf16_f32 v51, v179, -v183
    v_fma_f32 v192, v215, v184, -v192
    v_fma_f32 v196, v215, v188, -v196
    v_mfma_f32_32x32x16_bf16 v[136:151], a[96:99], v[120:123], v[136:151]
    v_fma_f32 v193, v215, v185, -v193
    v_fma_f32 v197, v215, v189, -v197
    v_fma_f32 v194, v215, v186, -v194
    v_fma_f32 v198, v215, v190, -v198
    v_fma_f32 v195, v215, v187, -v195
    v_fma_f32 v199, v215, v191, -v199
    v_cvt_pk_bf16_f32 v52, v192, -v196
    v_mfma_f32_32x32x16_bf16 v[152:167], a[100:103], v[120:123], v[152:167]
    buffer_load_dwordx4 a[196:199], v209, s[36:39], 0 offen offset:2048 sc1
    v_cvt_pk_bf16_f32 v53, v193, -v197
    v_cvt_pk_bf16_f32 v54, v194, -v198
    v_cvt_pk_bf16_f32 v55, v195, -v199
    v_fma_f32 v168, v214, v176, -v168
    v_fma_f32 v172, v214, v180, -v172
    v_mfma_f32_32x32x16_bf16 v[224:239], a[96:99], v[124:127], v[224:239]
    v_fma_f32 v169, v214, v177, -v169
    v_fma_f32 v173, v214, v181, -v173
    v_fma_f32 v170, v214, v178, -v170
    v_fma_f32 v174, v214, v182, -v174
    v_fma_f32 v171, v214, v179, -v171
    v_fma_f32 v175, v214, v183, -v175
    v_cvt_pk_bf16_f32 v56, v168, -v172
    v_mfma_f32_32x32x16_bf16 v[240:255], a[100:103], v[124:127], v[240:255]
    buffer_load_dwordx4 a[200:203], v208, s[36:39], 0 offen offset:3072 sc1
    s_waitcnt vmcnt(9)
    v_cvt_pk_bf16_f32 v57, v169, -v173
    v_cvt_pk_bf16_f32 v58, v170, -v174
    v_cvt_pk_bf16_f32 v59, v171, -v175
    v_fma_f32 v184, v215, v192, -v184
    v_mfma_f32_32x32x16_bf16 v[136:151], a[104:107], v[128:131], v[136:151]
    buffer_load_dwordx4 a[204:207], v209, s[36:39], 0 offen offset:3072 sc1
    v_fma_f32 v188, v215, v196, -v188
    v_fma_f32 v185, v215, v193, -v185
    v_fma_f32 v189, v215, v197, -v189
    v_fma_f32 v186, v215, v194, -v186
    v_fma_f32 v190, v215, v198, -v190
    v_mfma_f32_32x32x16_bf16 v[152:167], a[108:111], v[128:131], v[152:167]
    v_fma_f32 v187, v215, v195, -v187
    v_fma_f32 v191, v215, v199, -v191
    v_cvt_pk_bf16_f32 v60, v184, -v188
    v_cvt_pk_bf16_f32 v61, v185, -v189
    v_cvt_pk_bf16_f32 v62, v186, -v190
    v_cvt_pk_bf16_f32 v63, v187, -v191
    v_fma_f32 v176, v214, v168, -v176
    v_mfma_f32_32x32x16_bf16 v[224:239], a[104:107], v[132:135], v[224:239]
    buffer_load_dwordx4 a[208:211], v208, s[36:39], s65 offen offset:0 sc1
    v_fma_f32 v180, v214, v172, -v180
    v_fma_f32 v177, v214, v169, -v177
    v_fma_f32 v181, v214, v173, -v181
    v_fma_f32 v178, v214, v170, -v178
    v_fma_f32 v182, v214, v174, -v182
    v_mfma_f32_32x32x16_bf16 v[240:255], a[108:111], v[132:135], v[240:255]
    s_waitcnt vmcnt(9)
    v_fma_f32 v179, v214, v171, -v179
    v_fma_f32 v183, v214, v175, -v183
    v_cvt_pk_bf16_f32 v64, v176, -v180
    v_cvt_pk_bf16_f32 v65, v177, -v181
    v_cvt_pk_bf16_f32 v66, v178, -v182
    v_mfma_f32_32x32x16_bf16 v[136:151], a[112:115], a[176:179], v[136:151]
    buffer_load_dwordx4 a[212:215], v209, s[36:39], s65 offen offset:0 sc1
    v_cvt_pk_bf16_f32 v67, v179, -v183
    v_fma_f32 v192, v215, v184, -v192
    v_fma_f32 v196, v215, v188, -v196
    v_fma_f32 v193, v215, v185, -v193
    v_fma_f32 v197, v215, v189, -v197
    v_mfma_f32_32x32x16_bf16 v[152:167], a[116:119], a[176:179], v[152:167]
    v_fma_f32 v194, v215, v186, -v194
    v_fma_f32 v198, v215, v190, -v198
    v_fma_f32 v195, v215, v187, -v195
    v_fma_f32 v199, v215, v191, -v199
    v_cvt_pk_bf16_f32 v68, v192, -v196
    v_cvt_pk_bf16_f32 v69, v193, -v197
    v_cvt_pk_bf16_f32 v70, v194, -v198
    v_mfma_f32_32x32x16_bf16 v[224:239], a[112:115], a[180:183], v[224:239]
    buffer_load_dwordx4 a[216:219], v208, s[36:39], s65 offen offset:1024 sc1
    v_cvt_pk_bf16_f32 v71, v195, -v199
    v_fma_f32 v168, v214, v176, -v168
    v_fma_f32 v172, v214, v180, -v172
    v_fma_f32 v169, v214, v177, -v169
    v_fma_f32 v173, v214, v181, -v173
    v_mfma_f32_32x32x16_bf16 v[240:255], a[116:119], a[180:183], v[240:255]
    s_waitcnt vmcnt(9)
    v_cmp_ne_u32 vcc, v19, v14
    s_nop 0
    s_and_b32 vcc_lo, vcc_lo, 0xfffffff
    s_cbranch_scc1 L_pl5
L_pd5:
    s_waitcnt vmcnt(7)
    v_mfma_f32_32x32x16_bf16 v[136:151], a[120:123], a[184:187], v[136:151]
    buffer_load_dwordx4 a[220:223], v209, s[36:39], s65 offen offset:1024 sc1
    v_fma_f32 v170, v214, v178, -v170
    v_fma_f32 v174, v214, v182, -v174
    v_fma_f32 v171, v214, v179, -v171
    v_fma_f32 v175, v214, v183, -v175
    v_cvt_pk_bf16_f32 v72, v168, -v172
    v_mfma_f32_32x32x16_bf16 v[152:167], a[124:127], a[184:187], v[152:167]
    buffer_load_dwordx4 a[224:227], v208, s[36:39], s65 offen offset:2048 sc1
    ds_read_b64_tr_b16 a[0:1], v16 offset:8192
    ds_read_b64_tr_b16 a[2:3], v16 offset:9216
    v_cvt_pk_bf16_f32 v73, v169, -v173
    v_cvt_pk_bf16_f32 v74, v170, -v174
    v_mfma_f32_32x32x16_bf16 v[224:239], a[120:123], a[188:191], v[224:239]
    ds_read_b64_tr_b16 a[4:5], v17 offset:8192
    ds_read_b64_tr_b16 a[6:7], v17 offset:9216
    v_cvt_pk_bf16_f32 v75, v171, -v175
    v_fma_f32 v184, v215, v192, -v184
    v_fma_f32 v188, v215, v196, -v188
    v_fma_f32 v185, v215, v193, -v185
    v_fma_f32 v189, v215, v197, -v189
    v_mfma_f32_32x32x16_bf16 v[240:255], a[124:127], a[188:191], v[240:255]
    buffer_load_dwordx4 a[228:231], v209, s[36:39], s65 offen offset:2048 sc1
    s_waitcnt vmcnt(8)
    v_fma_f32 v186, v215, v194, -v186
    v_fma_f32 v190, v215, v198, -v190
    v_fma_f32 v187, v215, v195, -v187
    v_fma_f32 v191, v215, v199, -v191
    v_mfma_f32_32x32x16_bf16 v[136:151], a[128:131], a[192:195], v[136:151]
    v_add_u32 v208, 28672, v208
    v_add_u32 v209, 28672, v209
    ds_read_b64_tr_b16 a[8:9], v16 offset:10240
    ds_read_b64_tr_b16 a[10:11], v16 offset:11264
    v_cvt_pk_bf16_f32 v76, v184, -v188
    v_cvt_pk_bf16_f32 v77, v185, -v189
    v_mfma_f32_32x32x16_bf16 v[152:167], a[132:135], a[192:195], v[152:167]
    buffer_load_dwordx4 v[80:83], v210, s[36:39], 0 offen offset:0 sc1
    ds_read_b64_tr_b16 a[12:13], v17 offset:10240
    ds_read_b64_tr_b16 a[14:15], v17 offset:11264
    v_cvt_pk_bf16_f32 v78, v186, -v190
    v_cvt_pk_bf16_f32 v79, v187, -v191
    v_mfma_f32_32x32x16_bf16 v[224:239], a[128:131], a[196:199], v[224:239]
    s_barrier
    v_mfma_f32_32x32x16_bf16 v[240:255], a[132:135], a[196:199], v[240:255]
    buffer_load_dwordx4 v[84:87], v211, s[36:39], 0 offen offset:0 sc1
    ds_read_b64_tr_b16 a[16:17], v16 offset:0
    ds_read_b64_tr_b16 a[18:19], v16 offset:1024
    s_waitcnt vmcnt(8)
    v_mov_b32 v23, 0
    v_mfma_f32_32x32x16_bf16 v[136:151], a[136:139], a[200:203], v[136:151]
    buffer_atomic_or v23, v22, s[36:39], s58 offen offset:384 sc0 sc1
    ds_read_b64_tr_b16 a[20:21], v17 offset:0
    ds_read_b64_tr_b16 a[22:23], v17 offset:1024
    v_mfma_f32_32x32x16_bf16 v[152:167], a[140:143], a[200:203], v[152:167]
    v_mfma_f32_32x32x16_bf16 v[224:239], a[136:139], a[204:207], v[224:239]
    buffer_load_dwordx4 v[88:91], v210, s[36:39], 0 offen offset:1024 sc1
    ds_read_b64_tr_b16 a[24:25], v16 offset:2048
    ds_read_b64_tr_b16 a[26:27], v16 offset:3072
    v_mfma_f32_32x32x16_bf16 v[240:255], a[140:143], a[204:207], v[240:255]
    buffer_load_dwordx4 v[92:95], v211, s[36:39], 0 offen offset:1024 sc1
    ds_read_b64_tr_b16 a[28:29], v17 offset:2048
    ds_read_b64_tr_b16 a[30:31], v17 offset:3072
    s_waitcnt vmcnt(9)
    v_mfma_f32_32x32x16_bf16 v[136:151], a[144:147], a[208:211], v[136:151]
    v_mfma_f32_32x32x16_bf16 v[152:167], a[148:151], a[208:211], v[152:167]
    buffer_load_dwordx4 v[96:99], v210, s[36:39], 0 offen offset:2048 sc1
    ds_read_b64_tr_b16 a[32:33], v16 offset:4096
    ds_read_b64_tr_b16 a[34:35], v16 offset:5120
    v_mfma_f32_32x32x16_bf16 v[224:239], a[144:147], a[212:215], v[224:239]
    ds_read_b64_tr_b16 a[36:37], v17 offset:4096
    ds_read_b64_tr_b16 a[38:39], v17 offset:5120
    v_mfma_f32_32x32x16_bf16 v[240:255], a[148:151], a[212:215], v[240:255]
    buffer_load_dwordx4 v[100:103], v211, s[36:39], 0 offen offset:2048 sc1
    s_waitcnt vmcnt(9)
    v_mfma_f32_32x32x16_bf16 v[136:151], a[152:155], a[216:219], v[136:151]
    ds_read_b64_tr_b16 a[40:41], v16 offset:6144
    ds_read_b64_tr_b16 a[42:43], v16 offset:7168
    v_mfma_f32_32x32x16_bf16 v[152:167], a[156:159], a[216:219], v[152:167]
    buffer_load_dwordx4 v[104:107], v210, s[36:39], 0 offen offset:3072 sc1
    ds_read_b64_tr_b16 a[44:45], v17 offset:6144
    ds_read_b64_tr_b16 a[46:47], v17 offset:7168
    v_mfma_f32_32x32x16_bf16 v[224:239], a[152:155], a[220:223], v[224:239]
    v_mfma_f32_32x32x16_bf16 v[240:255], a[156:159], a[220:223], v[240:255]
    buffer_load_dwordx4 v[108:111], v211, s[36:39], 0 offen offset:3072 sc1
    s_waitcnt vmcnt(9)
    v_mfma_f32_32x32x16_bf16 v[136:151], a[160:163], a[224:227], v[136:151]
    buffer_load_dwordx4 v[112:115], v210, s[36:39], s65 offen offset:0 sc1
    v_mfma_f32_32x32x16_bf16 v[152:167], a[164:167], a[224:227], v[152:167]
    v_mfma_f32_32x32x16_bf16 v[224:239], a[160:163], a[228:231], v[224:239]
    buffer_load_dwordx4 v[116:119], v211, s[36:39], s65 offen offset:0 sc1
    s_waitcnt vmcnt(9)
    v_swap_b32 v82, v84
    v_swap_b32 v83, v85
    v_mfma_f32_32x32x16_bf16 v[240:255], a[164:167], a[228:231], v[240:255]
    s_nop 0
    v_mfma_f32_32x32x16_bf16 v[136:151], v[24:27], v[80:83], v[136:151]
    buffer_load_dwordx4 v[120:123], v210, s[36:39], s65 offen offset:1024 sc1
    v_mfma_f32_32x32x16_bf16 v[152:167], v[28:31], v[80:83], v[152:167]
    s_waitcnt vmcnt(9)
    v_cmp_ne_u32 vcc, v19, v23
    s_nop 0
    s_and_b32 vcc_lo, vcc_lo, 0x3fff
    s_cbranch_scc1 L_pl4
L_pd4:
    v_mfma_f32_32x32x16_bf16 v[224:239], v[24:27], v[84:87], v[224:239]
    buffer_load_dwordx4 v[124:127], v211, s[36:39], s65 offen offset:1024 sc1
    s_waitcnt vmcnt(8)
    v_swap_b32 v90, v92
    v_swap_b32 v91, v93
    v_mfma_f32_32x32x16_bf16 v[240:255], v[28:31], v[84:87], v[240:255]
    s_nop 0
    v_mfma_f32_32x32x16_bf16 v[136:151], v[32:35], v[88:91], v[136:151]
    buffer_load_dwordx4 v[128:131], v210, s[36:39], s65 offen offset:2048 sc1
    v_mfma_f32_32x32x16_bf16 v[152:167], v[36:39], v[88:91], v[152:167]
    buffer_load_dwordx4 v[132:135], v211, s[36:39], s65 offen offset:2048 sc1
    v_mfma_f32_32x32x16_bf16 v[224:239], v[32:35], v[92:95], v[224:239]
    s_waitcnt vmcnt(8)
    v_swap_b32 v98, v100
    v_swap_b32 v99, v101
    v_mfma_f32_32x32x16_bf16 v[240:255], v[36:39], v[92:95], v[240:255]
    buffer_load_dwordx4 a[56:59], v208, s[36:39], 0 offen offset:0 sc1
    v_mfma_f32_32x32x16_bf16 v[136:151], v[40:43], v[96:99], v[136:151]
    v_mfma_f32_32x32x16_bf16 v[152:167], v[44:47], v[96:99], v[152:167]
    buffer_load_dwordx4 a[64:67], v208, s[36:39], 0 offen offset:1024 sc1
    v_mfma_f32_32x32x16_bf16 v[224:239], v[40:43], v[100:103], v[224:239]
    s_waitcnt vmcnt(8)
    v_swap_b32 v106, v108
    v_swap_b32 v107, v109
    v_mfma_f32_32x32x16_bf16 v[240:255], v[44:47], v[100:103], v[240:255]
    buffer_load_dwordx4 a[72:75], v208, s[36:39], 0 offen offset:2048 sc1
    v_mfma_f32_32x32x16_bf16 v[136:151], v[48:51], v[104:107], v[136:151]
    v_mfma_f32_32x32x16_bf16 v[152:167], v[52:55], v[104:107], v[152:167]
    buffer_load_dwordx4 a[80:83], v208, s[36:39], 0 offen offset:3072 sc1
    v_mfma_f32_32x32x16_bf16 v[224:239], v[48:51], v[108:111], v[224:239]
    buffer_load_dwordx4 a[88:91], v208, s[36:39], s65 offen offset:0 sc1
    s_waitcnt vmcnt(9)
    v_swap_b32 v114, v116
    v_swap_b32 v115, v117
    v_mfma_f32_32x32x16_bf16 v[240:255], v[52:55], v[108:111], v[240:255]
    s_nop 0
    v_mfma_f32_32x32x16_bf16 v[136:151], v[56:59], v[112:115], v[136:151]
    buffer_load_dwordx4 a[96:99], v208, s[36:39], s65 offen offset:1024 sc1
    v_mfma_f32_32x32x16_bf16 v[152:167], v[60:63], v[112:115], v[152:167]
    v_mfma_f32_32x32x16_bf16 v[224:239], v[56:59], v[116:119], v[224:239]
    buffer_load_dwordx4 a[104:107], v208, s[36:39], s65 offen offset:2048 sc1
    s_waitcnt vmcnt(9)
    v_swap_b32 v122, v124
    v_swap_b32 v123, v125
    v_mfma_f32_32x32x16_bf16 v[240:255], v[60:63], v[116:119], v[240:255]
    s_nop 0
    v_mfma_f32_32x32x16_bf16 v[136:151], v[64:67], v[120:123], v[136:151]
    buffer_load_dwordx4 a[60:63], v209, s[36:39], 0 offen offset:0 sc1
    v_mfma_f32_32x32x16_bf16 v[152:167], v[68:71], v[120:123], v[152:167]
    v_mfma_f32_32x32x16_bf16 v[224:239], v[64:67], v[124:127], v[224:239]
    buffer_load_dwordx4 a[68:71], v209, s[36:39], 0 offen offset:1024 sc1
    s_waitcnt vmcnt(9)
    s_lshl_b32 s54, s44, 12
    v_swap_b32 v130, v132
    v_swap_b32 v131, v133
    v_and_b32 v4, 7, v2
    v_mfma_f32_32x32x16_bf16 v[240:255], v[68:71], v[124:127], v[240:255]
    buffer_load_dwordx4 a[76:79], v209, s[36:39], 0 offen offset:2048 sc1
    v_xor_b32 v4, v4, v3
    v_lshlrev_b32 v4, 4, v4
    v_lshl_add_u32 v4, v2, 8, v4
    v_add_u32 v4, s60, v4
    v_xor_b32 v5, 32, v4
    v_mfma_f32_32x32x16_bf16 v[136:151], v[72:75], v[128:131], v[136:151]
    v_xor_b32 v6, 64, v4
    v_xor_b32 v7, 96, v4
    v_lshrrev_b32 v220, 3, v0
    v_and_b32 v218, 7, v0
    v_lshlrev_b32 v218, 1, v218
    v_xor_b32 v218, v218, v220
    v_lshlrev_b32 v218, 4, v218
    v_mfma_f32_32x32x16_bf16 v[152:167], v[76:79], v[128:131], v[152:167]
    buffer_load_dwordx4 a[84:87], v209, s[36:39], 0 offen offset:3072 sc1
    v_lshl_add_u32 v218, v220, 8, v218
    v_add_u32 v218, s54, v218
    v_xor_b32 v219, 16, v218
    v_add_u32 v220, 57344, v218
    v_add_u32 v221, 57344, v219
    v_mfma_f32_32x32x16_bf16 v[224:239], v[72:75], v[132:135], v[224:239]
    v_mfma_f32_32x32x16_bf16 v[240:255], v[76:79], v[132:135], v[240:255]
    buffer_load_dwordx4 a[92:95], v209, s[36:39], s65 offen offset:0 sc1
    s_waitcnt lgkmcnt(0)
    s_waitcnt vmcnt(10)
    v_mfma_f32_32x32x16_bf16 v[136:151], a[168:171], a[56:59], v[136:151]
    v_mfma_f32_32x32x16_bf16 v[136:151], a[0:3], a[64:67], v[136:151]
    buffer_load_dwordx4 a[100:103], v209, s[36:39], s65 offen offset:1024 sc1
    s_waitcnt vmcnt(9)
    v_mfma_f32_32x32x16_bf16 v[136:151], a[8:11], a[72:75], v[136:151]
    v_mfma_f32_32x32x16_bf16 v[136:151], a[16:19], a[80:83], v[136:151]
    buffer_load_dwordx4 a[108:111], v209, s[36:39], s65 offen offset:2048 sc1
    s_waitcnt vmcnt(7)
    v_mfma_f32_32x32x16_bf16 v[136:151], a[24:27], a[88:91], v[136:151]
    v_add_u32 v208, 28672, v208
    v_add_u32 v209, 28672, v209
    buffer_load_dwordx4 v[200:203], v212, s[24:27], 0 offen
    v_mfma_f32_32x32x16_bf16 v[136:151], a[32:35], a[96:99], v[136:151]
    v_mfma_f32_32x32x16_bf16 v[136:151], a[40:43], a[104:107], v[136:151]
    buffer_load_dwordx4 v[204:207], v213, s[24:27], 0 offen
    v_mfma_f32_32x32x16_bf16 v[152:167], a[172:175], a[56:59], v[152:167]
    v_mfma_f32_32x32x16_bf16 v[152:167], a[4:7], a[64:67], v[152:167]
    v_mfma_f32_32x32x16_bf16 v[152:167], a[12:15], a[72:75], v[152:167]
    s_nop 7
    ds_write_b128 v4, v[136:139] offset:0
    v_mfma_f32_32x32x16_bf16 v[152:167], a[20:23], a[80:83], v[152:167]
    ds_write_b128 v5, v[140:143] offset:0
    v_mfma_f32_32x32x16_bf16 v[152:167], a[28:31], a[88:91], v[152:167]
    ds_write_b128 v6, v[144:147] offset:0
    v_mfma_f32_32x32x16_bf16 v[152:167], a[36:39], a[96:99], v[152:167]
    ds_write_b128 v7, v[148:151] offset:0
    v_mfma_f32_32x32x16_bf16 v[152:167], a[44:47], a[104:107], v[152:167]
    s_waitcnt vmcnt(7)
    v_mfma_f32_32x32x16_bf16 v[224:239], a[168:171], a[60:63], v[224:239]
    s_nop 4
    v_mfma_f32_32x32x16_bf16 v[224:239], a[0:3], a[68:71], v[224:239]
    s_waitcnt vmcnt(5)
    s_nop 4
    v_mfma_f32_32x32x16_bf16 v[224:239], a[8:11], a[76:79], v[224:239]
    ds_write_b128 v4, v[152:155] offset:128
    v_mfma_f32_32x32x16_bf16 v[224:239], a[16:19], a[84:87], v[224:239]
    s_waitcnt vmcnt(2)
    ds_write_b128 v5, v[156:159] offset:128
    v_mfma_f32_32x32x16_bf16 v[224:239], a[24:27], a[92:95], v[224:239]
    ds_write_b128 v6, v[160:163] offset:128
    v_mfma_f32_32x32x16_bf16 v[224:239], a[32:35], a[100:103], v[224:239]
    ds_write_b128 v7, v[164:167] offset:128
    v_mfma_f32_32x32x16_bf16 v[224:239], a[40:43], a[108:111], v[224:239]
    s_waitcnt vmcnt(0)
    v_lshlrev_b32 v168, 16, v200
    v_and_b32 v169, 0xffff0000, v200
    v_lshlrev_b32 v170, 16, v201
    v_and_b32 v171, 0xffff0000, v201
    v_lshlrev_b32 v172, 16, v202
    v_mfma_f32_32x32x16_bf16 v[240:255], a[172:175], a[60:63], v[240:255]
    s_nop 4
    v_and_b32 v173, 0xffff0000, v202
    v_mfma_f32_32x32x16_bf16 v[240:255], a[4:7], a[68:71], v[240:255]
    s_nop 4
    v_lshlrev_b32 v174, 16, v203
    v_mfma_f32_32x32x16_bf16 v[240:255], a[12:15], a[76:79], v[240:255]
    ds_write_b128 v4, v[224:227] offset:8192
    v_and_b32 v175, 0xffff0000, v203
    v_mfma_f32_32x32x16_bf16 v[240:255], a[20:23], a[84:87], v[240:255]
    ds_write_b128 v5, v[228:231] offset:8192
    v_lshlrev_b32 v176, 16, v204
    v_mfma_f32_32x32x16_bf16 v[240:255], a[28:31], a[92:95], v[240:255]
    ds_write_b128 v6, v[232:235] offset:8192
    v_and_b32 v177, 0xffff0000, v204
    v_mfma_f32_32x32x16_bf16 v[240:255], a[36:39], a[100:103], v[240:255]
    ds_write_b128 v7, v[236:239] offset:8192
    v_lshlrev_b32 v178, 16, v205
    v_mfma_f32_32x32x16_bf16 v[240:255], a[44:47], a[108:111], v[240:255]
    v_and_b32 v179, 0xffff0000, v205
    v_lshlrev_b32 v180, 16, v206
    v_and_b32 v181, 0xffff0000, v206
    v_lshlrev_b32 v182, 16, v207
    v_and_b32 v183, 0xffff0000, v207
    s_nop 4
    s_nop 4
    ds_write_b128 v4, v[240:243] offset:8320
    ds_write_b128 v5, v[244:247] offset:8320
    ds_write_b128 v6, v[248:251] offset:8320
    ds_write_b128 v7, v[252:255] offset:8320
    s_waitcnt lgkmcnt(0)
    s_barrier
    ds_read_b128 v[24:27], v218 offset:0
    ds_read_b128 v[28:31], v219 offset:0
    ds_read_b128 v[32:35], v218 offset:28672
    ds_read_b128 v[36:39], v219 offset:28672
    ds_read_b128 v[40:43], v220 offset:0
    ds_read_b128 v[44:47], v221 offset:0
    ds_read_b128 v[48:51], v220 offset:28672
    ds_read_b128 v[52:55], v221 offset:28672
    ds_read_b128 v[56:59], v218 offset:2048
    ds_read_b128 v[60:63], v219 offset:2048
    ds_read_b128 v[64:67], v218 offset:30720
    ds_read_b128 v[68:71], v219 offset:30720
    ds_read_b128 v[72:75], v220 offset:2048
    ds_read_b128 v[76:79], v221 offset:2048
    ds_read_b128 v[80:83], v220 offset:30720
    ds_read_b128 v[84:87], v221 offset:30720
    s_waitcnt lgkmcnt(15)
    v_pk_add_f32 v[168:169], v[168:169], v[24:25]
    v_pk_add_f32 v[170:171], v[170:171], v[26:27]
    s_waitcnt lgkmcnt(14)
    v_pk_add_f32 v[172:173], v[172:173], v[28:29]
    v_pk_add_f32 v[174:175], v[174:175], v[30:31]
    s_waitcnt lgkmcnt(13)
    v_pk_add_f32 v[168:169], v[168:169], v[32:33]
    v_pk_add_f32 v[170:171], v[170:171], v[34:35]
    s_waitcnt lgkmcnt(12)
    v_pk_add_f32 v[172:173], v[172:173], v[36:37]
    v_pk_add_f32 v[174:175], v[174:175], v[38:39]
    s_waitcnt lgkmcnt(11)
    v_pk_add_f32 v[168:169], v[168:169], v[40:41]
    v_pk_add_f32 v[170:171], v[170:171], v[42:43]
    s_waitcnt lgkmcnt(10)
    v_pk_add_f32 v[172:173], v[172:173], v[44:45]
    v_pk_add_f32 v[174:175], v[174:175], v[46:47]
    s_waitcnt lgkmcnt(9)
    v_pk_add_f32 v[168:169], v[168:169], v[48:49]
    v_pk_add_f32 v[170:171], v[170:171], v[50:51]
    s_waitcnt lgkmcnt(8)
    v_pk_add_f32 v[172:173], v[172:173], v[52:53]
    v_pk_add_f32 v[174:175], v[174:175], v[54:55]
    v_cvt_pk_bf16_f32 v200, v168, v169
    v_cvt_pk_bf16_f32 v201, v170, v171
    v_cvt_pk_bf16_f32 v202, v172, v173
    v_cvt_pk_bf16_f32 v203, v174, v175
    buffer_store_dwordx4 v[200:203], v212, s[40:43], 0 offen sc1
    s_waitcnt lgkmcnt(7)
    v_pk_add_f32 v[176:177], v[176:177], v[56:57]
    v_pk_add_f32 v[178:179], v[178:179], v[58:59]
    s_waitcnt lgkmcnt(6)
    v_pk_add_f32 v[180:181], v[180:181], v[60:61]
    v_pk_add_f32 v[182:183], v[182:183], v[62:63]
    s_waitcnt lgkmcnt(5)
    v_pk_add_f32 v[176:177], v[176:177], v[64:65]
    v_pk_add_f32 v[178:179], v[178:179], v[66:67]
    s_waitcnt lgkmcnt(4)
    v_pk_add_f32 v[180:181], v[180:181], v[68:69]
    v_pk_add_f32 v[182:183], v[182:183], v[70:71]
    s_waitcnt lgkmcnt(3)
    v_pk_add_f32 v[176:177], v[176:177], v[72:73]
    v_pk_add_f32 v[178:179], v[178:179], v[74:75]
    s_waitcnt lgkmcnt(2)
    v_pk_add_f32 v[180:181], v[180:181], v[76:77]
    v_pk_add_f32 v[182:183], v[182:183], v[78:79]
    s_waitcnt lgkmcnt(1)
    v_pk_add_f32 v[176:177], v[176:177], v[80:81]
    v_pk_add_f32 v[178:179], v[178:179], v[82:83]
    s_waitcnt lgkmcnt(0)
    v_pk_add_f32 v[180:181], v[180:181], v[84:85]
    v_pk_add_f32 v[182:183], v[182:183], v[86:87]
    v_cvt_pk_bf16_f32 v204, v176, v177
    v_cvt_pk_bf16_f32 v205, v178, v179
    v_cvt_pk_bf16_f32 v206, v180, v181
    v_cvt_pk_bf16_f32 v207, v182, v183
    buffer_store_dwordx4 v[204:207], v213, s[40:43], 0 offen sc1
    s_or_b32 s54, s2, s44
    s_cmp_lg_u32 s54, 0
    s_cbranch_scc1 L_gdone
    buffer_atomic_swap v19, v20, s[36:39], 0 offen offset:0 sc1
L_gdone:
    s_endpgm
L_pl1:
    s_mov_b32 s63, 0
L_pr1:
    s_sleep 1
    v_mov_b32 v23, 0
    buffer_atomic_or v23, v22, s[36:39], s58 offen offset:0 sc0 sc1
    s_add_u32 s63, s63, 1
    s_cmp_gt_u32 s63, 400000
    s_waitcnt vmcnt(0)
    s_cbranch_scc1 L_pd1
    v_cmp_ne_u32 vcc, v19, v23
    s_nop 1
    s_and_b32 vcc_lo, vcc_lo, 0x3fff
    s_cbranch_scc1 L_pr1
    s_branch L_pd1
L_pl2:
    s_mov_b32 s63, 0
L_pr2:
    s_sleep 1
    v_mov_b32 v23, 0
    buffer_atomic_or v23, v22, s[36:39], s58 offen offset:128 sc0 sc1
    s_add_u32 s63, s63, 1
    s_cmp_gt_u32 s63, 400000
    s_waitcnt vmcnt(0)
    s_cbranch_scc1 L_pd2
    v_cmp_ne_u32 vcc, v19, v23
    s_nop 1
    s_and_b32 vcc_lo, vcc_lo, 0x3fff
    s_cbranch_scc1 L_pr2
    s_branch L_pd2
L_pl3:
    s_mov_b32 s63, 0
L_pr3:
    s_sleep 1
    v_mov_b32 v23, 0
    buffer_atomic_or v23, v22, s[36:39], s58 offen offset:256 sc0 sc1
    s_add_u32 s63, s63, 1
    s_cmp_gt_u32 s63, 400000
    s_waitcnt vmcnt(0)
    s_cbranch_scc1 L_pd3
    v_cmp_ne_u32 vcc, v19, v23
    s_nop 1
    s_and_b32 vcc_lo, vcc_lo, 0x3fff
    s_cbranch_scc1 L_pr3
    s_branch L_pd3
L_pl4:
    s_mov_b32 s63, 0
L_pr4:
    s_sleep 1
    v_mov_b32 v23, 0
    buffer_atomic_or v23, v22, s[36:39], s58 offen offset:384 sc0 sc1
    s_add_u32 s63, s63, 1
    s_cmp_gt_u32 s63, 400000
    s_waitcnt vmcnt(0)
    s_cbranch_scc1 L_pd4
    v_cmp_ne_u32 vcc, v19, v23
    s_nop 1
    s_and_b32 vcc_lo, vcc_lo, 0x3fff
    s_cbranch_scc1 L_pr4
    s_branch L_pd4
L_pl5:
    s_mov_b32 s63, 0
L_pr5:
    s_sleep 1
    v_mov_b32 v14, 0
    buffer_atomic_or v14, v12, s[36:39], s62 offen offset:0 sc0 sc1
    s_add_u32 s63, s63, 1
    s_cmp_gt_u32 s63, 400000
    s_waitcnt vmcnt(0)
    s_cbranch_scc1 L_pd5
    v_cmp_ne_u32 vcc, v19, v14
    s_nop 1
    s_and_b32 vcc_lo, vcc_lo, 0xfffffff
    s_cbranch_scc1 L_pr5
    s_branch L_pd5
.p2align 12
L_fft:
    s_sub_u32 s52, s50, 28
    s_lshl2_add_u32 s45, s51, s52
    s_lshl_b32 s60, s44, 14
    s_lshr_b32 s52, s44, 1
    s_lshl_b32 s52, s52, 5
    s_and_b32 s53, s44, 1
    s_lshl_b32 s53, s53, 10
    s_add_u32 s52, s52, s53
    s_add_u32 s52, s52, s45
    s_mul_i32 s52, s52, 450
    s_add_u32 s52, s52, 2
    s_and_b32 s59, s52, 63
    s_sub_u32 s52, s52, s59
    s_mov_b32 s65, 230400
    s_mov_b32 s30, 921600
    s_mov_b32 s31, 0x20000
    s_mov_b32 s34, 921600
    s_mov_b32 s35, 0x20000
    v_lshrrev_b32 v3, 5, v0
    v_mul_u32_u24 v74, 114688, v3
    v_add_u32 v74, s52, v74
    v_add_u32 v64, v74, v1
    v_xor_b32 v75, 64, v1
    v_add_u32 v75, 27776, v75
    v_add_u32 v65, v74, v75
    v_xor_b32 v75, 128, v1
    v_add_u32 v75, 55552, v75
    v_add_u32 v66, v74, v75
    v_xor_b32 v75, 192, v1
    v_add_u32 v75, 83328, v75
    v_add_u32 v67, v74, v75
    s_waitcnt lgkmcnt(0)
    s_mov_b64 s[28:29], s[6:7]
    s_mov_b64 s[32:33], s[8:9]
    s_add_u32 m0, s60, 0
    s_nop 0
    buffer_load_dwordx4 v64, s[28:31], 0 offen offset:0 lds
    v_and_b32 v2, 31, v0
    v_cvt_f32_u32 v20, v2
    v_lshlrev_b32 v21, 2, v3
    v_cvt_f32_u32 v21, v21
    v_mul_f32 v18, 0x3d000000, v20
    v_mul_f32 v19, v18, v21
    v_fmamk_f32 v22, v18, 0x00000000, v19
    v_fmamk_f32 v23, v18, 0x3f800000, v19
    v_cos_f32 v24, v22
    v_cos_f32 v25, v23
    buffer_load_dwordx4 v65, s[28:31], 0 offen offset:1024 lds
    s_load_dword s49, s[22:23], 0
    v_sin_f32 v26, v22
    v_sin_f32 v27, v23
    v_cvt_pk_f16_f32 v28, v24, v25
    v_cvt_pk_f16_f32 v29, v26, v27
    v_accvgpr_write_b32 a64, v28
    v_accvgpr_write_b32 a72, v29
    v_xor_b32 v29, 0x80008000, v29
    v_accvgpr_write_b32 a80, v29
    v_fmamk_f32 v22, v18, 0x40000000, v19
    v_fmamk_f32 v23, v18, 0x40400000, v19
    buffer_load_dwordx4 v66, s[28:31], 0 offen offset:2048 lds
    v_cos_f32 v24, v22
    v_cos_f32 v25, v23
    v_sin_f32 v26, v22
    v_sin_f32 v27, v23
    v_cvt_pk_f16_f32 v28, v24, v25
    v_cvt_pk_f16_f32 v29, v26, v27
    v_accvgpr_write_b32 a65, v28
    v_accvgpr_write_b32 a73, v29
    v_xor_b32 v29, 0x80008000, v29
    v_accvgpr_write_b32 a81, v29
    buffer_load_dwordx4 v67, s[28:31], 0 offen offset:3072 lds
    s_mov_b32 s36, s22
    s_mov_b32 s37, s23
    s_mov_b32 s38, 13893632
    s_mov_b32 s39, 0x20000
    s_lshl2_add_u32 s58, s45, s44
    s_lshl_b32 s52, s45, 7
    s_add_u32 s52, s52, s60
    s_add_u32 s52, s52, 4718592
    s_lshr_b32 s53, s45, 1
    s_lshl_b32 s54, s44, 13
    s_add_u32 m0, s60, 4096
    s_nop 0
    buffer_load_dwordx4 v64, s[28:31], s65 offen offset:0 lds
    s_add_u32 s54, s54, 65536
    s_lshl_b32 s46, s44, 8
    s_add_u32 s46, s46, 49152
    s_lshl2_add_u32 s55, s44, 98304
    s_and_b32 s56, s59, 56
    s_bfe_u32 s59, s59, 0x20001
    s_lshl_b64 s[24:25], -1, s59
    s_add_u32 s57, s59, 32
    s_bfm_b64 s[26:27], s57, 0
    v_min_u32 v6, 1, v0
    buffer_load_dwordx4 v65, s[28:31], s65 offen offset:1024 lds
    v_lshlrev_b32 v6, 30, v6
    v_add_u32 v4, s54, v1
    v_and_b32 v76, 48, v0
    v_lshlrev_b32 v76, 1, v76
    v_and_b32 v75, 3, v0
    v_lshl_add_u32 v76, v75, 3, v76
    v_add_u32 v76, s56, v76
    v_bfe_u32 v75, v0, 2, 2
    v_mul_u32_u24 v75, 1088, v75
    v_add_u32 v75, s60, v75
    buffer_load_dwordx4 v66, s[28:31], s65 offen offset:2048 lds
    v_add_u32 v68, 0, v76
    v_and_b32 v68, 511, v68
    v_xor_b32 v68, v68, v75
    v_add_u32 v69, 128, v76
    v_and_b32 v69, 511, v69
    v_xor_b32 v69, v69, v75
    v_add_u32 v70, 256, v76
    v_and_b32 v70, 511, v70
    v_xor_b32 v70, v70, v75
    v_add_u32 v71, 384, v76
    v_and_b32 v71, 511, v71
    v_xor_b32 v71, v71, v75
    v_subrev_u32 v75, s59, v0
    v_xor_b32 v76, s53, v75
    v_and_b32 v76, 7, v76
    v_lshlrev_b32 v76, 4, v76
    v_ashrrev_i32 v75, 3, v75
    v_lshlrev_b32 v75, 16, v75
    v_add3_u32 v85, v75, v76, s52
    v_mov_b32 v75, 0x40000000
    v_cndmask_b32 v84, v75, v85, s[24:25]
    v_cndmask_b32 v86, v75, v85, s[26:27]
    v_mov_b32 v74, s55
    v_fmamk_f32 v22, v18, 0x41000000, v19
    v_fmamk_f32 v23, v18, 0x41100000, v19
    v_cos_f32 v24, v22
    v_cos_f32 v25, v23
    v_sin_f32 v26, v22
    v_sin_f32 v27, v23
    v_cvt_pk_f16_f32 v28, v24, v25
    v_cvt_pk_f16_f32 v29, v26, v27
    v_accvgpr_write_b32 a66, v28
    v_accvgpr_write_b32 a74, v29
    v_xor_b32 v29, 0x80008000, v29
    v_accvgpr_write_b32 a82, v29
    v_fmamk_f32 v22, v18, 0x41200000, v19
    v_fmamk_f32 v23, v18, 0x41300000, v19
    v_cos_f32 v24, v22
    v_cos_f32 v25, v23
    v_sin_f32 v26, v22
    v_sin_f32 v27, v23
    v_cvt_pk_f16_f32 v28, v24, v25
    v_cvt_pk_f16_f32 v29, v26, v27
    v_accvgpr_write_b32 a67, v28
    v_accvgpr_write_b32 a75, v29
    v_xor_b32 v29, 0x80008000, v29
    v_accvgpr_write_b32 a83, v29
    v_fmamk_f32 v22, v18, 0x41800000, v19
    v_fmamk_f32 v23, v18, 0x41880000, v19
    v_cos_f32 v24, v22
    v_cos_f32 v25, v23
    v_sin_f32 v26, v22
    v_sin_f32 v27, v23
    v_cvt_pk_f16_f32 v28, v24, v25
    v_cvt_pk_f16_f32 v29, v26, v27
    v_accvgpr_write_b32 a68, v28
    v_accvgpr_write_b32 a76, v29
    v_xor_b32 v29, 0x80008000, v29
    v_accvgpr_write_b32 a84, v29
    v_fmamk_f32 v22, v18, 0x41900000, v19
    v_fmamk_f32 v23, v18, 0x41980000, v19
    v_cos_f32 v24, v22
    v_cos_f32 v25, v23
    v_sin_f32 v26, v22
    v_sin_f32 v27, v23
    v_cvt_pk_f16_f32 v28, v24, v25
    v_cvt_pk_f16_f32 v29, v26, v27
    v_accvgpr_write_b32 a69, v28
    v_accvgpr_write_b32 a77, v29
    v_xor_b32 v29, 0x80008000, v29
    buffer_load_dwordx4 v67, s[28:31], s65 offen offset:3072 lds
    v_accvgpr_write_b32 a85, v29
    v_fmamk_f32 v22, v18, 0x41c00000, v19
    v_fmamk_f32 v23, v18, 0x41c80000, v19
    v_cos_f32 v24, v22
    v_cos_f32 v25, v23
    v_sin_f32 v26, v22
    v_sin_f32 v27, v23
    v_cvt_pk_f16_f32 v28, v24, v25
    v_cvt_pk_f16_f32 v29, v26, v27
    v_accvgpr_write_b32 a70, v28
    v_accvgpr_write_b32 a78, v29
    v_xor_b32 v29, 0x80008000, v29
    v_accvgpr_write_b32 a86, v29
    v_fmamk_f32 v22, v18, 0x41d00000, v19
    v_fmamk_f32 v23, v18, 0x41d80000, v19
    v_cos_f32 v24, v22
    s_add_u32 m0, s60, 8192
    s_nop 0
    buffer_load_dwordx4 v64, s[32:35], 0 offen offset:0 lds
    v_cos_f32 v25, v23
    v_sin_f32 v26, v22
    v_sin_f32 v27, v23
    v_cvt_pk_f16_f32 v28, v24, v25
    v_cvt_pk_f16_f32 v29, v26, v27
    v_accvgpr_write_b32 a71, v28
    v_accvgpr_write_b32 a79, v29
    v_xor_b32 v29, 0x80008000, v29
    v_accvgpr_write_b32 a87, v29
    v_fmamk_f32 v19, v20, 0x3c800000, v19
    v_fmamk_f32 v22, v18, 0x00000000, v19
    v_fmamk_f32 v23, v18, 0x3f800000, v19
    v_cos_f32 v24, v22
    v_cos_f32 v25, v23
    v_sin_f32 v26, v22
    v_sin_f32 v27, v23
    buffer_load_dwordx4 v65, s[32:35], 0 offen offset:1024 lds
    v_cvt_pk_f16_f32 v28, v24, v25
    v_cvt_pk_f16_f32 v29, v26, v27
    v_accvgpr_write_b32 a112, v28
    v_accvgpr_write_b32 a120, v29
    v_xor_b32 v29, 0x80008000, v29
    v_accvgpr_write_b32 a128, v29
    v_fmamk_f32 v22, v18, 0x40000000, v19
    v_fmamk_f32 v23, v18, 0x40400000, v19
    v_cos_f32 v24, v22
    v_cos_f32 v25, v23
    v_sin_f32 v26, v22
    v_sin_f32 v27, v23
    v_cvt_pk_f16_f32 v28, v24, v25
    v_cvt_pk_f16_f32 v29, v26, v27
    v_accvgpr_write_b32 a113, v28
    v_accvgpr_write_b32 a121, v29
    buffer_load_dwordx4 v66, s[32:35], 0 offen offset:2048 lds
    v_xor_b32 v29, 0x80008000, v29
    v_accvgpr_write_b32 a129, v29
    v_fmamk_f32 v22, v18, 0x41000000, v19
    v_fmamk_f32 v23, v18, 0x41100000, v19
    v_cos_f32 v24, v22
    v_cos_f32 v25, v23
    v_sin_f32 v26, v22
    v_sin_f32 v27, v23
    v_cvt_pk_f16_f32 v28, v24, v25
    v_cvt_pk_f16_f32 v29, v26, v27
    v_accvgpr_write_b32 a114, v28
    v_accvgpr_write_b32 a122, v29
    v_xor_b32 v29, 0x80008000, v29
    v_accvgpr_write_b32 a130, v29
    v_fmamk_f32 v22, v18, 0x41200000, v19
    v_fmamk_f32 v23, v18, 0x41300000, v19
    buffer_load_dwordx4 v67, s[32:35], 0 offen offset:3072 lds
    v_cos_f32 v24, v22
    v_cos_f32 v25, v23
    v_sin_f32 v26, v22
    v_sin_f32 v27, v23
    v_cvt_pk_f16_f32 v28, v24, v25
    v_cvt_pk_f16_f32 v29, v26, v27
    v_accvgpr_write_b32 a115, v28
    v_accvgpr_write_b32 a123, v29
    v_xor_b32 v29, 0x80008000, v29
    v_accvgpr_write_b32 a131, v29
    v_fmamk_f32 v22, v18, 0x41800000, v19
    v_fmamk_f32 v23, v18, 0x41880000, v19
    v_cos_f32 v24, v22
    v_cos_f32 v25, v23
    v_sin_f32 v26, v22
    v_sin_f32 v27, v23
    s_add_u32 m0, s60, 12288
    s_nop 0
    buffer_load_dwordx4 v64, s[32:35], s65 offen offset:0 lds
    v_cvt_pk_f16_f32 v28, v24, v25
    v_cvt_pk_f16_f32 v29, v26, v27
    v_accvgpr_write_b32 a116, v28
    v_accvgpr_write_b32 a124, v29
    v_xor_b32 v29, 0x80008000, v29
    v_accvgpr_write_b32 a132, v29
    v_fmamk_f32 v22, v18, 0x41900000, v19
    v_fmamk_f32 v23, v18, 0x41980000, v19
    v_cos_f32 v24, v22
    v_cos_f32 v25, v23
    v_sin_f32 v26, v22
    v_sin_f32 v27, v23
    v_cvt_pk_f16_f32 v28, v24, v25
    v_cvt_pk_f16_f32 v29, v26, v27
    v_accvgpr_write_b32 a117, v28
    v_accvgpr_write_b32 a125, v29
    buffer_load_dwordx4 v65, s[32:35], s65 offen offset:1024 lds
    v_xor_b32 v29, 0x80008000, v29
    v_accvgpr_write_b32 a133, v29
    v_fmamk_f32 v22, v18, 0x41c00000, v19
    v_fmamk_f32 v23, v18, 0x41c80000, v19
    v_cos_f32 v24, v22
    v_cos_f32 v25, v23
    v_sin_f32 v26, v22
    v_sin_f32 v27, v23
    v_cvt_pk_f16_f32 v28, v24, v25
    v_cvt_pk_f16_f32 v29, v26, v27
    v_accvgpr_write_b32 a118, v28
    v_accvgpr_write_b32 a126, v29
    v_xor_b32 v29, 0x80008000, v29
    v_accvgpr_write_b32 a134, v29
    v_fmamk_f32 v22, v18, 0x41d00000, v19
    v_fmamk_f32 v23, v18, 0x41d80000, v19
    buffer_load_dwordx4 v66, s[32:35], s65 offen offset:2048 lds
    v_cos_f32 v24, v22
    v_cos_f32 v25, v23
    v_sin_f32 v26, v22
    v_sin_f32 v27, v23
    v_cvt_pk_f16_f32 v28, v24, v25
    v_cvt_pk_f16_f32 v29, v26, v27
    v_accvgpr_write_b32 a119, v28
    v_accvgpr_write_b32 a127, v29
    v_xor_b32 v29, 0x80008000, v29
    v_accvgpr_write_b32 a135, v29
    v_add_f32 v18, 0x3c800000, v18
    v_mul_f32 v19, v18, v21
    v_fmamk_f32 v22, v18, 0x00000000, v19
    v_fmamk_f32 v23, v18, 0x3f800000, v19
    v_cos_f32 v24, v22
    v_cos_f32 v25, v23
    buffer_load_dwordx4 v67, s[32:35], s65 offen offset:3072 lds
    v_sin_f32 v26, v22
    v_sin_f32 v27, v23
    v_cvt_pk_f16_f32 v28, v24, v25
    v_cvt_pk_f16_f32 v29, v26, v27
    v_accvgpr_write_b32 a88, v28
    v_accvgpr_write_b32 a96, v29
    v_xor_b32 v29, 0x80008000, v29
    v_accvgpr_write_b32 a104, v29
    v_fmamk_f32 v22, v18, 0x40000000, v19
    v_fmamk_f32 v23, v18, 0x40400000, v19
    v_cos_f32 v24, v22
    v_cos_f32 v25, v23
    v_sin_f32 v26, v22
    v_sin_f32 v27, v23
    v_cvt_pk_f16_f32 v28, v24, v25
    v_cvt_pk_f16_f32 v29, v26, v27
    v_accvgpr_write_b32 a89, v28
    v_accvgpr_write_b32 a97, v29
    v_xor_b32 v29, 0x80008000, v29
    v_accvgpr_write_b32 a105, v29
    v_fmamk_f32 v22, v18, 0x41000000, v19
    v_fmamk_f32 v23, v18, 0x41100000, v19
    v_cos_f32 v24, v22
    v_cos_f32 v25, v23
    v_sin_f32 v26, v22
    v_sin_f32 v27, v23
    v_cvt_pk_f16_f32 v28, v24, v25
    v_cvt_pk_f16_f32 v29, v26, v27
    v_accvgpr_write_b32 a90, v28
    v_accvgpr_write_b32 a98, v29
    v_xor_b32 v29, 0x80008000, v29
    v_accvgpr_write_b32 a106, v29
    v_fmamk_f32 v22, v18, 0x41200000, v19
    v_fmamk_f32 v23, v18, 0x41300000, v19
    v_cos_f32 v24, v22
    v_cos_f32 v25, v23
    v_sin_f32 v26, v22
    v_sin_f32 v27, v23
    v_cvt_pk_f16_f32 v28, v24, v25
    v_cvt_pk_f16_f32 v29, v26, v27
    v_accvgpr_write_b32 a91, v28
    v_accvgpr_write_b32 a99, v29
    v_xor_b32 v29, 0x80008000, v29
    v_accvgpr_write_b32 a107, v29
    v_fmamk_f32 v22, v18, 0x41800000, v19
    v_fmamk_f32 v23, v18, 0x41880000, v19
    v_cos_f32 v24, v22
    v_cos_f32 v25, v23
    v_sin_f32 v26, v22
    v_sin_f32 v27, v23
    v_cvt_pk_f16_f32 v28, v24, v25
    v_cvt_pk_f16_f32 v29, v26, v27
    v_accvgpr_write_b32 a92, v28
    v_accvgpr_write_b32 a100, v29
    v_xor_b32 v29, 0x80008000, v29
    v_accvgpr_write_b32 a108, v29
    v_fmamk_f32 v22, v18, 0x41900000, v19
    v_fmamk_f32 v23, v18, 0x41980000, v19
    v_cos_f32 v24, v22
    v_cos_f32 v25, v23
    v_sin_f32 v26, v22
    v_sin_f32 v27, v23
    v_cvt_pk_f16_f32 v28, v24, v25
    v_cvt_pk_f16_f32 v29, v26, v27
    v_accvgpr_write_b32 a93, v28
    v_accvgpr_write_b32 a101, v29
    v_xor_b32 v29, 0x80008000, v29
    v_accvgpr_write_b32 a109, v29
    v_fmamk_f32 v22, v18, 0x41c00000, v19
    v_fmamk_f32 v23, v18, 0x41c80000, v19
    v_cos_f32 v24, v22
    v_cos_f32 v25, v23
    s_mov_b64 exec, 0
    s_cmp_eq_u32 s44, 0
    s_cbranch_scc1 L_padf0
    s_cmp_eq_u32 s44, 1
    s_cbranch_scc1 L_padf1
    s_cmp_eq_u32 s44, 2
    s_cbranch_scc1 L_padf2
L_backf:
    s_mov_b64 exec, -1
L_warmf:
    s_waitcnt vmcnt(8)
    ds_read_b64_tr_b16 v[128:129], v68 offset:0
    ds_read_b64_tr_b16 v[130:131], v68 offset:4096
    ds_read_b64_tr_b16 v[132:133], v68 offset:512
    ds_read_b64_tr_b16 v[134:135], v68 offset:4608
    ds_read_b64_tr_b16 v[136:137], v69 offset:0
    ds_read_b64_tr_b16 v[138:139], v69 offset:4096
    ds_read_b64_tr_b16 v[140:141], v69 offset:512
    ds_read_b64_tr_b16 v[142:143], v69 offset:4608
    ds_read_b64_tr_b16 v[144:145], v70 offset:0
    ds_read_b64_tr_b16 v[146:147], v70 offset:4096
    ds_read_b64_tr_b16 v[148:149], v70 offset:512
    ds_read_b64_tr_b16 v[150:151], v70 offset:4608
    ds_read_b64_tr_b16 v[152:153], v71 offset:0
    ds_read_b64_tr_b16 v[154:155], v71 offset:4096
    ds_read_b64_tr_b16 v[156:157], v71 offset:512
    ds_read_b64_tr_b16 v[158:159], v71 offset:4608
    v_mov_b32 v72, 0
    s_waitcnt lgkmcnt(0)
    s_mul_i32 s49, s49, 0x9e3779b1
    s_add_u32 s49, s49, 0x7f4a7c15
    v_mov_b32 v5, s49
    s_mov_b64 exec, s[24:25]
    v_pk_maximum3_f16 v72, v72, v128, v128 neg_lo:[0,0,1] neg_hi:[0,0,1]
    v_pk_maximum3_f16 v72, v72, v129, v129 neg_lo:[0,0,1] neg_hi:[0,0,1]
    v_pk_maximum3_f16 v72, v72, v130, v130 neg_lo:[0,0,1] neg_hi:[0,0,1]
    v_pk_maximum3_f16 v72, v72, v131, v131 neg_lo:[0,0,1] neg_hi:[0,0,1]
    v_pk_maximum3_f16 v72, v72, v132, v132 neg_lo:[0,0,1] neg_hi:[0,0,1]
    v_pk_maximum3_f16 v72, v72, v133, v133 neg_lo:[0,0,1] neg_hi:[0,0,1]
    v_pk_maximum3_f16 v72, v72, v134, v134 neg_lo:[0,0,1] neg_hi:[0,0,1]
    v_pk_maximum3_f16 v72, v72, v135, v135 neg_lo:[0,0,1] neg_hi:[0,0,1]
    s_mov_b64 exec, s[26:27]
    v_pk_maximum3_f16 v72, v72, v152, v152 neg_lo:[0,0,1] neg_hi:[0,0,1]
    v_pk_maximum3_f16 v72, v72, v153, v153 neg_lo:[0,0,1] neg_hi:[0,0,1]
    v_pk_maximum3_f16 v72, v72, v154, v154 neg_lo:[0,0,1] neg_hi:[0,0,1]
    v_pk_maximum3_f16 v72, v72, v155, v155 neg_lo:[0,0,1] neg_hi:[0,0,1]
    v_pk_maximum3_f16 v72, v72, v156, v156 neg_lo:[0,0,1] neg_hi:[0,0,1]
    v_pk_maximum3_f16 v72, v72, v157, v157 neg_lo:[0,0,1] neg_hi:[0,0,1]
    v_pk_maximum3_f16 v72, v72, v158, v158 neg_lo:[0,0,1] neg_hi:[0,0,1]
    v_pk_maximum3_f16 v72, v72, v159, v159 neg_lo:[0,0,1] neg_hi:[0,0,1]
    s_mov_b64 exec, -1
    v_pk_maximum3_f16 v72, v72, v136, v136 neg_lo:[0,0,1] neg_hi:[0,0,1]
    v_pk_maximum3_f16 v72, v72, v137, v137 neg_lo:[0,0,1] neg_hi:[0,0,1]
    v_pk_maximum3_f16 v72, v72, v138, v138 neg_lo:[0,0,1] neg_hi:[0,0,1]
    v_pk_maximum3_f16 v72, v72, v139, v139 neg_lo:[0,0,1] neg_hi:[0,0,1]
    v_pk_maximum3_f16 v72, v72, v140, v140 neg_lo:[0,0,1] neg_hi:[0,0,1]
    v_pk_maximum3_f16 v72, v72, v141, v141 neg_lo:[0,0,1] neg_hi:[0,0,1]
    v_pk_maximum3_f16 v72, v72, v142, v142 neg_lo:[0,0,1] neg_hi:[0,0,1]
    v_pk_maximum3_f16 v72, v72, v143, v143 neg_lo:[0,0,1] neg_hi:[0,0,1]
    v_pk_maximum3_f16 v72, v72, v144, v144 neg_lo:[0,0,1] neg_hi:[0,0,1]
    v_pk_maximum3_f16 v72, v72, v145, v145 neg_lo:[0,0,1] neg_hi:[0,0,1]
    v_pk_maximum3_f16 v72, v72, v146, v146 neg_lo:[0,0,1] neg_hi:[0,0,1]
    v_pk_maximum3_f16 v72, v72, v147, v147 neg_lo:[0,0,1] neg_hi:[0,0,1]
    v_pk_maximum3_f16 v72, v72, v148, v148 neg_lo:[0,0,1] neg_hi:[0,0,1]
    v_pk_maximum3_f16 v72, v72, v149, v149 neg_lo:[0,0,1] neg_hi:[0,0,1]
    v_pk_maximum3_f16 v72, v72, v150, v150 neg_lo:[0,0,1] neg_hi:[0,0,1]
    v_pk_maximum3_f16 v72, v72, v151, v151 neg_lo:[0,0,1] neg_hi:[0,0,1]
    s_waitcnt vmcnt(0)
    ds_read_b64_tr_b16 v[160:161], v68 offset:8192
    ds_read_b64_tr_b16 v[162:163], v68 offset:12288
    ds_read_b64_tr_b16 v[164:165], v68 offset:8704
    ds_read_b64_tr_b16 v[166:167], v68 offset:12800
    ds_read_b64_tr_b16 v[168:169], v69 offset:8192
    ds_read_b64_tr_b16 v[170:171], v69 offset:12288
    ds_read_b64_tr_b16 v[172:173], v69 offset:8704
    ds_read_b64_tr_b16 v[174:175], v69 offset:12800
    ds_read_b64_tr_b16 v[176:177], v70 offset:8192
    ds_read_b64_tr_b16 v[178:179], v70 offset:12288
    ds_read_b64_tr_b16 v[180:181], v70 offset:8704
    ds_read_b64_tr_b16 v[182:183], v70 offset:12800
    ds_read_b64_tr_b16 v[184:185], v71 offset:8192
    ds_read_b64_tr_b16 v[186:187], v71 offset:12288
    ds_read_b64_tr_b16 v[188:189], v71 offset:8704
    ds_read_b64_tr_b16 v[190:191], v71 offset:12800
    s_waitcnt lgkmcnt(0)
    s_mov_b64 exec, s[24:25]
    v_pk_maximum3_f16 v72, v72, v160, v160 neg_lo:[0,0,1] neg_hi:[0,0,1]
    v_pk_maximum3_f16 v72, v72, v161, v161 neg_lo:[0,0,1] neg_hi:[0,0,1]
    v_pk_maximum3_f16 v72, v72, v162, v162 neg_lo:[0,0,1] neg_hi:[0,0,1]
    v_pk_maximum3_f16 v72, v72, v163, v163 neg_lo:[0,0,1] neg_hi:[0,0,1]
    v_pk_maximum3_f16 v72, v72, v164, v164 neg_lo:[0,0,1] neg_hi:[0,0,1]
    v_pk_maximum3_f16 v72, v72, v165, v165 neg_lo:[0,0,1] neg_hi:[0,0,1]
    v_pk_maximum3_f16 v72, v72, v166, v166 neg_lo:[0,0,1] neg_hi:[0,0,1]
    v_pk_maximum3_f16 v72, v72, v167, v167 neg_lo:[0,0,1] neg_hi:[0,0,1]
    s_mov_b64 exec, s[26:27]
    v_pk_maximum3_f16 v72, v72, v184, v184 neg_lo:[0,0,1] neg_hi:[0,0,1]
    v_pk_maximum3_f16 v72, v72, v185, v185 neg_lo:[0,0,1] neg_hi:[0,0,1]
    v_pk_maximum3_f16 v72, v72, v186, v186 neg_lo:[0,0,1] neg_hi:[0,0,1]
    v_pk_maximum3_f16 v72, v72, v187, v187 neg_lo:[0,0,1] neg_hi:[0,0,1]
    v_pk_maximum3_f16 v72, v72, v188, v188 neg_lo:[0,0,1] neg_hi:[0,0,1]
    v_pk_maximum3_f16 v72, v72, v189, v189 neg_lo:[0,0,1] neg_hi:[0,0,1]
    v_pk_maximum3_f16 v72, v72, v190, v190 neg_lo:[0,0,1] neg_hi:[0,0,1]
    v_pk_maximum3_f16 v72, v72, v191, v191 neg_lo:[0,0,1] neg_hi:[0,0,1]
    s_mov_b64 exec, -1
    v_pk_maximum3_f16 v72, v72, v168, v168 neg_lo:[0,0,1] neg_hi:[0,0,1]
    v_pk_maximum3_f16 v72, v72, v169, v169 neg_lo:[0,0,1] neg_hi:[0,0,1]
    v_pk_maximum3_f16 v72, v72, v170, v170 neg_lo:[0,0,1] neg_hi:[0,0,1]
    v_pk_maximum3_f16 v72, v72, v171, v171 neg_lo:[0,0,1] neg_hi:[0,0,1]
    v_pk_maximum3_f16 v72, v72, v172, v172 neg_lo:[0,0,1] neg_hi:[0,0,1]
    v_pk_maximum3_f16 v72, v72, v173, v173 neg_lo:[0,0,1] neg_hi:[0,0,1]
    v_pk_maximum3_f16 v72, v72, v174, v174 neg_lo:[0,0,1] neg_hi:[0,0,1]
    v_pk_maximum3_f16 v72, v72, v175, v175 neg_lo:[0,0,1] neg_hi:[0,0,1]
    v_pk_maximum3_f16 v72, v72, v176, v176 neg_lo:[0,0,1] neg_hi:[0,0,1]
    v_pk_maximum3_f16 v72, v72, v177, v177 neg_lo:[0,0,1] neg_hi:[0,0,1]
    v_pk_maximum3_f16 v72, v72, v178, v178 neg_lo:[0,0,1] neg_hi:[0,0,1]
    v_pk_maximum3_f16 v72, v72, v179, v179 neg_lo:[0,0,1] neg_hi:[0,0,1]
    v_pk_maximum3_f16 v72, v72, v180, v180 neg_lo:[0,0,1] neg_hi:[0,0,1]
    v_pk_maximum3_f16 v72, v72, v181, v181 neg_lo:[0,0,1] neg_hi:[0,0,1]
    v_pk_maximum3_f16 v72, v72, v182, v182 neg_lo:[0,0,1] neg_hi:[0,0,1]
    v_pk_maximum3_f16 v72, v72, v183, v183 neg_lo:[0,0,1] neg_hi:[0,0,1]
    v_pk_max_u16 v72, v72, v72 op_sel:[0,1] op_sel_hi:[1,0]
    v_bfe_u32 v72, v72, 7, 8
    s_nop 1
    v_max_u32_dpp v72, v72, v72 quad_perm:[1,0,3,2] row_mask:0xf bank_mask:0xf
    s_nop 1
    v_max_u32_dpp v72, v72, v72 quad_perm:[2,3,0,1] row_mask:0xf bank_mask:0xf
    s_nop 1
    v_max_u32_dpp v72, v72, v72 row_half_mirror row_mask:0xf bank_mask:0xf
    s_nop 1
    v_max_u32_dpp v72, v72, v72 row_mirror row_mask:0xf bank_mask:0xf
    v_mov_b32 v73, v72
    s_nop 1
    v_permlane16_swap_b32 v72, v73
    v_max_u32 v72, v72, v73
    v_mov_b32 v73, v72
    s_nop 1
    v_permlane32_swap_b32 v72, v73
    v_max_u32 v72, v72, v73
    ds_write_b32 v74, v72
    v_mov_b32 v74, 98304
    s_waitcnt lgkmcnt(0)
    s_barrier
    ds_read_b128 v[80:83], v74
    s_movk_i32 s53, 252
    s_waitcnt lgkmcnt(0)
    v_max3_u32 v80, v80, v81, v82
    v_max_u32 v80, v80, v83
    v_med3_u32 v80, v80, 1, s53
    v_sub_u32 v78, 253, v80
    v_lshlrev_b32 v79, 23, v78
    v_lshlrev_b32 v78, 7, v78
    v_dot2_f32_bf16 v192, v128, v78, 0
    v_dot2_f32_bf16 v193, v128, v79, 0
    v_dot2_f32_bf16 v194, v129, v78, 0
    v_dot2_f32_bf16 v195, v129, v79, 0
    v_dot2_f32_bf16 v196, v130, v78, 0
    v_dot2_f32_bf16 v197, v130, v79, 0
    v_dot2_f32_bf16 v198, v131, v78, 0
    v_dot2_f32_bf16 v199, v131, v79, 0
    v_cvt_pk_f16_f32 v128, v192, v193
    v_cvt_pk_f16_f32 v129, v194, v195
    v_cvt_pk_f16_f32 v130, v196, v197
    v_cvt_pk_f16_f32 v131, v198, v199
    s_mov_b32 s62, 0
    buffer_store_dwordx4 v[128:131], v84, s[36:39], s62 offen sc1
    v_dot2_f32_bf16 v200, v132, v78, 0
    v_dot2_f32_bf16 v201, v132, v79, 0
    v_dot2_f32_bf16 v202, v133, v78, 0
    v_dot2_f32_bf16 v203, v133, v79, 0
    v_dot2_f32_bf16 v204, v134, v78, 0
    v_dot2_f32_bf16 v205, v134, v79, 0
    v_dot2_f32_bf16 v206, v135, v78, 0
    v_dot2_f32_bf16 v207, v135, v79, 0
    v_cvt_pk_f16_f32 v132, v200, v201
    v_cvt_pk_f16_f32 v133, v202, v203
    v_cvt_pk_f16_f32 v134, v204, v205
    v_cvt_pk_f16_f32 v135, v206, v207
    s_mov_b32 s62, 4096
    buffer_store_dwordx4 v[132:135], v84, s[36:39], s62 offen sc1
    v_dot2_f32_bf16 v192, v136, v78, 0
    v_dot2_f32_bf16 v193, v136, v79, 0
    v_dot2_f32_bf16 v194, v137, v78, 0
    v_dot2_f32_bf16 v195, v137, v79, 0
    v_dot2_f32_bf16 v196, v138, v78, 0
    v_dot2_f32_bf16 v197, v138, v79, 0
    v_dot2_f32_bf16 v198, v139, v78, 0
    v_dot2_f32_bf16 v199, v139, v79, 0
    v_cvt_pk_f16_f32 v136, v192, v193
    v_cvt_pk_f16_f32 v137, v194, v195
    v_cvt_pk_f16_f32 v138, v196, v197
    v_cvt_pk_f16_f32 v139, v198, v199
    s_mov_b32 s62, 524288
    buffer_store_dwordx4 v[136:139], v85, s[36:39], s62 offen sc1
    v_dot2_f32_bf16 v200, v140, v78, 0
    v_dot2_f32_bf16 v201, v140, v79, 0
    v_dot2_f32_bf16 v202, v141, v78, 0
    v_dot2_f32_bf16 v203, v141, v79, 0
    v_dot2_f32_bf16 v204, v142, v78, 0
    v_dot2_f32_bf16 v205, v142, v79, 0
    v_dot2_f32_bf16 v206, v143, v78, 0
    v_dot2_f32_bf16 v207, v143, v79, 0
    v_cvt_pk_f16_f32 v140, v200, v201
    v_cvt_pk_f16_f32 v141, v202, v203
    v_cvt_pk_f16_f32 v142, v204, v205
    v_cvt_pk_f16_f32 v143, v206, v207
    s_mov_b32 s62, 528384
    buffer_store_dwordx4 v[140:143], v85, s[36:39], s62 offen sc1
    v_dot2_f32_bf16 v192, v144, v78, 0
    v_dot2_f32_bf16 v193, v144, v79, 0
    v_dot2_f32_bf16 v194, v145, v78, 0
    v_dot2_f32_bf16 v195, v145, v79, 0
    v_dot2_f32_bf16 v196, v146, v78, 0
    v_dot2_f32_bf16 v197, v146, v79, 0
    v_dot2_f32_bf16 v198, v147, v78, 0
    v_dot2_f32_bf16 v199, v147, v79, 0
    v_cvt_pk_f16_f32 v144, v192, v193
    v_cvt_pk_f16_f32 v145, v194, v195
    v_cvt_pk_f16_f32 v146, v196, v197
    v_cvt_pk_f16_f32 v147, v198, v199
    s_mov_b32 s62, 1048576
    buffer_store_dwordx4 v[144:147], v85, s[36:39], s62 offen sc1
    v_dot2_f32_bf16 v200, v148, v78, 0
    v_dot2_f32_bf16 v201, v148, v79, 0
    v_dot2_f32_bf16 v202, v149, v78, 0
    v_dot2_f32_bf16 v203, v149, v79, 0
    v_dot2_f32_bf16 v204, v150, v78, 0
    v_dot2_f32_bf16 v205, v150, v79, 0
    v_dot2_f32_bf16 v206, v151, v78, 0
L_padf0:
    s_cbranch_execz L_backf
    v_dot2_f32_bf16 v207, v151, v79, 0
    v_cvt_pk_f16_f32 v148, v200, v201
    v_cvt_pk_f16_f32 v149, v202, v203
    v_cvt_pk_f16_f32 v150, v204, v205
    v_cvt_pk_f16_f32 v151, v206, v207
    s_mov_b32 s62, 1052672
    buffer_store_dwordx4 v[148:151], v85, s[36:39], s62 offen sc1
    v_dot2_f32_bf16 v192, v152, v78, 0
    v_dot2_f32_bf16 v193, v152, v79, 0
    v_dot2_f32_bf16 v194, v153, v78, 0
    v_dot2_f32_bf16 v195, v153, v79, 0
    v_dot2_f32_bf16 v196, v154, v78, 0
    v_dot2_f32_bf16 v197, v154, v79, 0
    v_dot2_f32_bf16 v198, v155, v78, 0
    v_dot2_f32_bf16 v199, v155, v79, 0
    v_cvt_pk_f16_f32 v152, v192, v193
    v_cvt_pk_f16_f32 v153, v194, v195
    v_cvt_pk_f16_f32 v154, v196, v197
    v_cvt_pk_f16_f32 v155, v198, v199
    s_mov_b32 s62, 1572864
    buffer_store_dwordx4 v[152:155], v86, s[36:39], s62 offen sc1
    v_dot2_f32_bf16 v200, v156, v78, 0
    v_dot2_f32_bf16 v201, v156, v79, 0
    v_dot2_f32_bf16 v202, v157, v78, 0
    v_dot2_f32_bf16 v203, v157, v79, 0
    v_dot2_f32_bf16 v204, v158, v78, 0
    v_dot2_f32_bf16 v205, v158, v79, 0
    v_dot2_f32_bf16 v206, v159, v78, 0
    v_dot2_f32_bf16 v207, v159, v79, 0
    v_cvt_pk_f16_f32 v156, v200, v201
    v_cvt_pk_f16_f32 v157, v202, v203
    v_cvt_pk_f16_f32 v158, v204, v205
    v_cvt_pk_f16_f32 v159, v206, v207
    s_mov_b32 s62, 1576960
    buffer_store_dwordx4 v[156:159], v86, s[36:39], s62 offen sc1
    v_dot2_f32_bf16 v192, v160, v78, 0
    v_dot2_f32_bf16 v193, v160, v79, 0
    v_dot2_f32_bf16 v194, v161, v78, 0
    v_dot2_f32_bf16 v195, v161, v79, 0
    v_dot2_f32_bf16 v196, v162, v78, 0
    v_dot2_f32_bf16 v197, v162, v79, 0
    v_dot2_f32_bf16 v198, v163, v78, 0
    v_dot2_f32_bf16 v199, v163, v79, 0
    v_cvt_pk_f16_f32 v160, v192, v193
    v_cvt_pk_f16_f32 v161, v194, v195
    v_cvt_pk_f16_f32 v162, v196, v197
    v_cvt_pk_f16_f32 v163, v198, v199
    s_mov_b32 s62, 8192
    buffer_store_dwordx4 v[160:163], v84, s[36:39], s62 offen sc1
    v_dot2_f32_bf16 v200, v164, v78, 0
    v_dot2_f32_bf16 v201, v164, v79, 0
    v_dot2_f32_bf16 v202, v165, v78, 0
    v_dot2_f32_bf16 v203, v165, v79, 0
    v_dot2_f32_bf16 v204, v166, v78, 0
    v_dot2_f32_bf16 v205, v166, v79, 0
    v_dot2_f32_bf16 v206, v167, v78, 0
    v_dot2_f32_bf16 v207, v167, v79, 0
    v_cvt_pk_f16_f32 v164, v200, v201
    v_cvt_pk_f16_f32 v165, v202, v203
    v_cvt_pk_f16_f32 v166, v204, v205
    v_cvt_pk_f16_f32 v167, v206, v207
    s_mov_b32 s62, 12288
    buffer_store_dwordx4 v[164:167], v84, s[36:39], s62 offen sc1
    v_dot2_f32_bf16 v192, v168, v78, 0
    v_dot2_f32_bf16 v193, v168, v79, 0
    v_dot2_f32_bf16 v194, v169, v78, 0
    v_dot2_f32_bf16 v195, v169, v79, 0
    v_dot2_f32_bf16 v196, v170, v78, 0
    v_dot2_f32_bf16 v197, v170, v79, 0
    v_dot2_f32_bf16 v198, v171, v78, 0
    v_dot2_f32_bf16 v199, v171, v79, 0
    v_cvt_pk_f16_f32 v168, v192, v193
    v_cvt_pk_f16_f32 v169, v194, v195
    v_cvt_pk_f16_f32 v170, v196, v197
    v_cvt_pk_f16_f32 v171, v198, v199
    s_mov_b32 s62, 532480
    buffer_store_dwordx4 v[168:171], v85, s[36:39], s62 offen sc1
    v_dot2_f32_bf16 v200, v172, v78, 0
    v_dot2_f32_bf16 v201, v172, v79, 0
    v_dot2_f32_bf16 v202, v173, v78, 0
    v_dot2_f32_bf16 v203, v173, v79, 0
    v_dot2_f32_bf16 v204, v174, v78, 0
    v_dot2_f32_bf16 v205, v174, v79, 0
    v_dot2_f32_bf16 v206, v175, v78, 0
    v_dot2_f32_bf16 v207, v175, v79, 0
    v_cvt_pk_f16_f32 v172, v200, v201
    v_cvt_pk_f16_f32 v173, v202, v203
    v_cvt_pk_f16_f32 v174, v204, v205
    v_cvt_pk_f16_f32 v175, v206, v207
    s_mov_b32 s62, 536576
    buffer_store_dwordx4 v[172:175], v85, s[36:39], s62 offen sc1
    v_dot2_f32_bf16 v192, v176, v78, 0
    v_dot2_f32_bf16 v193, v176, v79, 0
    v_dot2_f32_bf16 v194, v177, v78, 0
    v_dot2_f32_bf16 v195, v177, v79, 0
    v_dot2_f32_bf16 v196, v178, v78, 0
    v_dot2_f32_bf16 v197, v178, v79, 0
    v_dot2_f32_bf16 v198, v179, v78, 0
    v_dot2_f32_bf16 v199, v179, v79, 0
    v_cvt_pk_f16_f32 v176, v192, v193
    v_cvt_pk_f16_f32 v177, v194, v195
    v_cvt_pk_f16_f32 v178, v196, v197
    v_cvt_pk_f16_f32 v179, v198, v199
    s_mov_b32 s62, 1056768
    buffer_store_dwordx4 v[176:179], v85, s[36:39], s62 offen sc1
    v_dot2_f32_bf16 v200, v180, v78, 0
    v_dot2_f32_bf16 v201, v180, v79, 0
    v_dot2_f32_bf16 v202, v181, v78, 0
    v_dot2_f32_bf16 v203, v181, v79, 0
    v_dot2_f32_bf16 v204, v182, v78, 0
    v_dot2_f32_bf16 v205, v182, v79, 0
    v_dot2_f32_bf16 v206, v183, v78, 0
    v_dot2_f32_bf16 v207, v183, v79, 0
    v_cvt_pk_f16_f32 v180, v200, v201
    v_cvt_pk_f16_f32 v181, v202, v203
    v_cvt_pk_f16_f32 v182, v204, v205
    v_cvt_pk_f16_f32 v183, v206, v207
    s_mov_b32 s62, 1060864
    buffer_store_dwordx4 v[180:183], v85, s[36:39], s62 offen sc1
    v_dot2_f32_bf16 v192, v184, v78, 0
    v_dot2_f32_bf16 v193, v184, v79, 0
    v_dot2_f32_bf16 v194, v185, v78, 0
    v_dot2_f32_bf16 v195, v185, v79, 0
    v_dot2_f32_bf16 v196, v186, v78, 0
    v_dot2_f32_bf16 v197, v186, v79, 0
    v_dot2_f32_bf16 v198, v187, v78, 0
    v_dot2_f32_bf16 v199, v187, v79, 0
    v_cvt_pk_f16_f32 v184, v192, v193
    v_cvt_pk_f16_f32 v185, v194, v195
    v_cvt_pk_f16_f32 v186, v196, v197
    v_cvt_pk_f16_f32 v187, v198, v199
    s_mov_b32 s62, 1581056
    buffer_store_dwordx4 v[184:187], v86, s[36:39], s62 offen sc1
    v_dot2_f32_bf16 v200, v188, v78, 0
    v_dot2_f32_bf16 v201, v188, v79, 0
    v_dot2_f32_bf16 v202, v189, v78, 0
    v_dot2_f32_bf16 v203, v189, v79, 0
    v_dot2_f32_bf16 v204, v190, v78, 0
    v_dot2_f32_bf16 v205, v190, v79, 0
    v_dot2_f32_bf16 v206, v191, v78, 0
    v_dot2_f32_bf16 v207, v191, v79, 0
    v_cvt_pk_f16_f32 v188, v200, v201
    v_cvt_pk_f16_f32 v189, v202, v203
    v_cvt_pk_f16_f32 v190, v204, v205
    v_cvt_pk_f16_f32 v191, v206, v207
    s_mov_b32 s62, 1585152
    buffer_store_dwordx4 v[188:191], v86, s[36:39], s62 offen sc1
    v_sin_f32 v26, v22
    v_sin_f32 v27, v23
    v_cvt_pk_f16_f32 v28, v24, v25
    v_cvt_pk_f16_f32 v29, v26, v27
    v_accvgpr_write_b32 a94, v28
    v_accvgpr_write_b32 a102, v29
    v_xor_b32 v29, 0x80008000, v29
    v_accvgpr_write_b32 a110, v29
    v_fmamk_f32 v22, v18, 0x41d00000, v19
    v_fmamk_f32 v23, v18, 0x41d80000, v19
    v_cos_f32 v24, v22
    v_cos_f32 v25, v23
    v_sin_f32 v26, v22
    v_sin_f32 v27, v23
    v_cvt_pk_f16_f32 v28, v24, v25
    v_cvt_pk_f16_f32 v29, v26, v27
    v_accvgpr_write_b32 a95, v28
    v_accvgpr_write_b32 a103, v29
    v_xor_b32 v29, 0x80008000, v29
    v_accvgpr_write_b32 a111, v29
    v_mul_f32 v18, 0x3a000000, v20
    v_mul_f32 v19, v18, v21
    v_fmamk_f32 v22, v18, 0x00000000, v19
    v_fmamk_f32 v23, v18, 0x3f800000, v19
    v_cos_f32 v24, v22
    v_cos_f32 v25, v23
    v_sin_f32 v26, v22
    v_sin_f32 v27, v23
    v_cvt_pk_f16_f32 v32, v24, v25
    v_cvt_pk_f16_f32 v40, v26, v27
    v_fmamk_f32 v22, v18, 0x40000000, v19
    v_fmamk_f32 v23, v18, 0x40400000, v19
    v_cos_f32 v24, v22
    v_cos_f32 v25, v23
    v_sin_f32 v26, v22
    v_sin_f32 v27, v23
    v_cvt_pk_f16_f32 v33, v24, v25
    v_cvt_pk_f16_f32 v41, v26, v27
    v_fmamk_f32 v22, v18, 0x41000000, v19
    v_fmamk_f32 v23, v18, 0x41100000, v19
    v_cos_f32 v24, v22
    v_cos_f32 v25, v23
    v_sin_f32 v26, v22
    v_sin_f32 v27, v23
    v_cvt_pk_f16_f32 v34, v24, v25
    v_cvt_pk_f16_f32 v42, v26, v27
    v_fmamk_f32 v22, v18, 0x41200000, v19
    v_fmamk_f32 v23, v18, 0x41300000, v19
    v_cos_f32 v24, v22
    v_cos_f32 v25, v23
    v_sin_f32 v26, v22
    v_sin_f32 v27, v23
    v_cvt_pk_f16_f32 v35, v24, v25
    v_cvt_pk_f16_f32 v43, v26, v27
    v_fmamk_f32 v22, v18, 0x41800000, v19
    v_fmamk_f32 v23, v18, 0x41880000, v19
    v_cos_f32 v24, v22
    v_cos_f32 v25, v23
    v_sin_f32 v26, v22
    v_sin_f32 v27, v23
    v_cvt_pk_f16_f32 v36, v24, v25
    v_cvt_pk_f16_f32 v44, v26, v27
    v_fmamk_f32 v22, v18, 0x41900000, v19
    v_fmamk_f32 v23, v18, 0x41980000, v19
    v_cos_f32 v24, v22
    v_cos_f32 v25, v23
    v_sin_f32 v26, v22
    v_sin_f32 v27, v23
    v_cvt_pk_f16_f32 v37, v24, v25
    v_cvt_pk_f16_f32 v45, v26, v27
    v_fmamk_f32 v22, v18, 0x41c00000, v19
    v_fmamk_f32 v23, v18, 0x41c80000, v19
    v_cos_f32 v24, v22
    v_cos_f32 v25, v23
    v_sin_f32 v26, v22
    v_sin_f32 v27, v23
    v_cvt_pk_f16_f32 v38, v24, v25
    v_cvt_pk_f16_f32 v46, v26, v27
    v_fmamk_f32 v22, v18, 0x41d00000, v19
    v_fmamk_f32 v23, v18, 0x41d80000, v19
    v_cos_f32 v24, v22
    v_cos_f32 v25, v23
    v_sin_f32 v26, v22
    v_sin_f32 v27, v23
    v_cvt_pk_f16_f32 v39, v24, v25
    v_cvt_pk_f16_f32 v47, v26, v27
    v_add_f32 v18, 0x3c800000, v18
    v_mul_f32 v19, v18, v21
    v_fmamk_f32 v22, v18, 0x00000000, v19
    v_fmamk_f32 v23, v18, 0x3f800000, v19
    v_cos_f32 v24, v22
    v_cos_f32 v25, v23
    v_sin_f32 v26, v22
    v_sin_f32 v27, v23
    v_cvt_pk_f16_f32 v48, v24, v25
    v_cvt_pk_f16_f32 v56, v26, v27
    v_fmamk_f32 v22, v18, 0x40000000, v19
    v_fmamk_f32 v23, v18, 0x40400000, v19
    v_cos_f32 v24, v22
    v_cos_f32 v25, v23
    v_sin_f32 v26, v22
    v_sin_f32 v27, v23
    v_cvt_pk_f16_f32 v49, v24, v25
    v_cvt_pk_f16_f32 v57, v26, v27
    v_fmamk_f32 v22, v18, 0x41000000, v19
    v_fmamk_f32 v23, v18, 0x41100000, v19
    v_cos_f32 v24, v22
    v_cos_f32 v25, v23
    v_sin_f32 v26, v22
    v_sin_f32 v27, v23
    s_mov_b32 s64, 0x40004000
    s_mov_b32 s65, 4096
    s_mov_b32 s66, 8192
    s_mov_b32 s67, 12288
    s_lshr_b32 s47, s58, 1
    s_lshl_b32 s47, s47, 7
    s_add_u32 s47, s47, 40960
    v_add_u32 v8, 32, v0
    v_and_b32 v8, 64, v8
    v_lshlrev_b32 v7, 3, v0
    v_lshl_add_u32 v7, v8, 24, v7
    v_add_u32 v16, 48, v0
    v_and_b32 v16, 64, v16
    v_lshlrev_b32 v15, 2, v0
    v_lshl_add_u32 v15, v16, 24, v15
    s_lshl_b32 s53, s58, 14
    s_add_u32 s52, s53, 4718592
    s_add_u32 s53, s53, 1048576
    s_lshl_b32 s56, s44, 1
    s_mul_i32 s54, s45, 37
    s_lshr_b32 s54, s54, 8
    s_and_b32 s55, s44, 1
    s_add_u32 s54, s54, s55
    s_mul_i32 s54, s54, 7
    s_add_u32 s54, s54, s45
    s_lshr_b32 s55, s44, 1
    s_lshl1_add_u32 s54, s54, s55
    s_lshl_b32 s54, s54, 9
    s_add_u32 s54, s54, 2883584
    s_cmp_eq_u32 s58, 111
    s_mov_b32 s55, 0x3a124925
    s_cselect_b32 s57, 0x39924925, s55
    s_mov_b32 s4, 0
    s_mov_b32 s5, 57344
    s_mov_b32 s6, 229376
    s_mov_b32 s7, 286720
    s_mov_b32 s8, 458752
    s_mov_b32 s9, 516096
    s_mov_b32 s10, 688128
    s_mov_b32 s11, 745472
    s_mov_b32 s12, 917504
    s_mov_b32 s13, 974848
    s_mov_b32 s14, 1146880
    s_mov_b32 s15, 1204224
    s_mov_b32 s16, 1376256
    s_mov_b32 s17, 1433600
    s_mov_b32 s18, 1605632
    s_mov_b32 s19, 1662976
    v_add_u32 v17, s52, v1
    v_add_u32 v96, s53, v1
    v_bfe_u32 v13, v2, 1, 3
    v_xor_b32 v13, s56, v13
    v_lshlrev_b32 v13, 4, v13
    v_lshl_add_u32 v13, v0, 7, v13
    v_xor_b32 v14, 16, v13
    v_mul_u32_u24 v10, 114688, v3
    v_lshl_add_u32 v10, v2, 4, v10
    v_add_u32 v10, s54, v10
    s_lshl3_add_u32 s48, s45, s46
    v_mov_b32 v81, v80
    v_mov_b32 v80, v5
    s_waitcnt vmcnt(0)
    buffer_atomic_swap_x2 v[80:81], v6, s[36:39], s48 offen offset:0 sc1
    s_cmp_ge_u32 s45, 28
    s_cbranch_scc1 L_end
    v_cvt_pk_f16_f32 v50, v24, v25
    v_cvt_pk_f16_f32 v58, v26, v27
    v_fmamk_f32 v22, v18, 0x41200000, v19
    v_fmamk_f32 v23, v18, 0x41300000, v19
    v_cos_f32 v24, v22
    v_cos_f32 v25, v23
    v_sin_f32 v26, v22
    v_sin_f32 v27, v23
    v_cvt_pk_f16_f32 v51, v24, v25
    v_cvt_pk_f16_f32 v59, v26, v27
    v_fmamk_f32 v22, v18, 0x41800000, v19
    v_fmamk_f32 v23, v18, 0x41880000, v19
    v_cos_f32 v24, v22
    v_cos_f32 v25, v23
    v_sin_f32 v26, v22
    v_sin_f32 v27, v23
    v_cvt_pk_f16_f32 v52, v24, v25
    v_cvt_pk_f16_f32 v60, v26, v27
    v_fmamk_f32 v22, v18, 0x41900000, v19
    v_fmamk_f32 v23, v18, 0x41980000, v19
    v_cos_f32 v24, v22
    v_cos_f32 v25, v23
    v_sin_f32 v26, v22
    v_sin_f32 v27, v23
    v_cvt_pk_f16_f32 v53, v24, v25
    v_cvt_pk_f16_f32 v61, v26, v27
    v_fmamk_f32 v22, v18, 0x41c00000, v19
    v_fmamk_f32 v23, v18, 0x41c80000, v19
    v_cos_f32 v24, v22
    v_cos_f32 v25, v23
    v_sin_f32 v26, v22
    v_sin_f32 v27, v23
    v_cvt_pk_f16_f32 v54, v24, v25
    v_cvt_pk_f16_f32 v62, v26, v27
    v_fmamk_f32 v22, v18, 0x41d00000, v19
    v_fmamk_f32 v23, v18, 0x41d80000, v19
    v_cos_f32 v24, v22
    v_cos_f32 v25, v23
    v_sin_f32 v26, v22
    v_sin_f32 v27, v23
    v_cvt_pk_f16_f32 v55, v24, v25
    v_cvt_pk_f16_f32 v63, v26, v27
    ds_write_b128 v4, v[32:35] offset:0
    ds_write_b128 v4, v[36:39] offset:1024
    ds_write_b128 v4, v[40:43] offset:2048
    ds_write_b128 v4, v[44:47] offset:3072
    ds_write_b128 v4, v[48:51] offset:4096
    ds_write_b128 v4, v[52:55] offset:5120
    ds_write_b128 v4, v[56:59] offset:6144
    ds_write_b128 v4, v[60:63] offset:7168
    v_mul_f32 v18, 0x3a000000, v20
    v_add_f32 v19, 0x42000000, v21
    v_mul_f32 v19, v18, v19
    v_fmamk_f32 v22, v18, 0x00000000, v19
    v_fmamk_f32 v23, v18, 0x3f800000, v19
    v_cos_f32 v24, v22
    v_cos_f32 v25, v23
    v_sin_f32 v26, v22
    v_sin_f32 v27, v23
    v_cvt_pk_f16_f32 v48, v24, v25
    v_cvt_pk_f16_f32 v56, v26, v27
    v_fmamk_f32 v22, v18, 0x40000000, v19
    v_fmamk_f32 v23, v18, 0x40400000, v19
    v_cos_f32 v24, v22
    v_cos_f32 v25, v23
    v_sin_f32 v26, v22
    v_sin_f32 v27, v23
    v_cvt_pk_f16_f32 v49, v24, v25
    v_cvt_pk_f16_f32 v57, v26, v27
    v_fmamk_f32 v22, v18, 0x41000000, v19
    v_fmamk_f32 v23, v18, 0x41100000, v19
    v_cos_f32 v24, v22
    v_cos_f32 v25, v23
    v_sin_f32 v26, v22
    v_sin_f32 v27, v23
    v_cvt_pk_f16_f32 v50, v24, v25
    v_cvt_pk_f16_f32 v58, v26, v27
    v_fmamk_f32 v22, v18, 0x41200000, v19
    v_fmamk_f32 v23, v18, 0x41300000, v19
    v_cos_f32 v24, v22
    v_cos_f32 v25, v23
    v_sin_f32 v26, v22
    v_sin_f32 v27, v23
    v_cvt_pk_f16_f32 v51, v24, v25
    v_cvt_pk_f16_f32 v59, v26, v27
    v_fmamk_f32 v22, v18, 0x41800000, v19
    v_fmamk_f32 v23, v18, 0x41880000, v19
    v_cos_f32 v24, v22
    v_cos_f32 v25, v23
    v_sin_f32 v26, v22
    v_sin_f32 v27, v23
    v_cvt_pk_f16_f32 v52, v24, v25
    v_cvt_pk_f16_f32 v60, v26, v27
    v_fmamk_f32 v22, v18, 0x41900000, v19
    v_fmamk_f32 v23, v18, 0x41980000, v19
    v_cos_f32 v24, v22
    v_cos_f32 v25, v23
    v_sin_f32 v26, v22
    v_sin_f32 v27, v23
    v_cvt_pk_f16_f32 v53, v24, v25
    v_cvt_pk_f16_f32 v61, v26, v27
    v_fmamk_f32 v22, v18, 0x41c00000, v19
    v_fmamk_f32 v23, v18, 0x41c80000, v19
    v_cos_f32 v24, v22
    v_cos_f32 v25, v23
    v_sin_f32 v26, v22
    v_sin_f32 v27, v23
    v_cvt_pk_f16_f32 v54, v24, v25
    v_cvt_pk_f16_f32 v62, v26, v27
    v_fmamk_f32 v22, v18, 0x41d00000, v19
    v_fmamk_f32 v23, v18, 0x41d80000, v19
    v_cos_f32 v24, v22
    v_cos_f32 v25, v23
    v_sin_f32 v26, v22
    v_sin_f32 v27, v23
    v_cvt_pk_f16_f32 v55, v24, v25
    v_cvt_pk_f16_f32 v63, v26, v27
    v_mov_b32 v16, 0
    buffer_atomic_or v16, v15, s[36:39], s47 offen offset:0 sc0 sc1
    s_waitcnt vmcnt(0)
    v_cmp_ne_u32 vcc, v5, v16
    s_nop 0
    s_and_b32 vcc_lo, vcc_lo, 0xffff
    s_cbranch_scc1 L_pl6
L_pd6:
    v_mov_b32 v8, 0
    v_mov_b32 v9, 0
    buffer_atomic_or_x2 v[8:9], v7, s[36:39], s46 offen offset:0 sc0 sc1
    buffer_load_dwordx4 a[0:3], v96, s[36:39], 0 offen offset:0 sc1
    buffer_load_dwordx4 a[4:7], v96, s[36:39], 0 offen offset:1024 sc1
    buffer_load_dwordx4 a[16:19], v96, s[36:39], s65 offen offset:0 sc1
    buffer_load_dwordx4 a[20:23], v96, s[36:39], s65 offen offset:1024 sc1
    buffer_load_dwordx4 a[8:11], v96, s[36:39], 0 offen offset:2048 sc1
    buffer_load_dwordx4 a[12:15], v96, s[36:39], 0 offen offset:3072 sc1
    buffer_load_dwordx4 a[24:27], v96, s[36:39], s65 offen offset:2048 sc1
    buffer_load_dwordx4 a[28:31], v96, s[36:39], s65 offen offset:3072 sc1
    buffer_load_dwordx4 a[32:35], v96, s[36:39], s66 offen offset:0 sc1
    buffer_load_dwordx4 a[36:39], v96, s[36:39], s66 offen offset:1024 sc1
    buffer_load_dwordx4 a[48:51], v96, s[36:39], s67 offen offset:0 sc1
    buffer_load_dwordx4 a[52:55], v96, s[36:39], s67 offen offset:1024 sc1
    s_waitcnt vmcnt(12)
    v_cmp_ne_u32 vcc, v5, v8
    s_nop 0
    s_and_b32 vcc_lo, vcc_lo, 0xffffffff
    s_cbranch_scc1 L_pl7
L_pd7:
    v_mov_b32 v28, v9
    s_nop 1
    v_permlane32_swap_b32 v9, v28
    v_mov_b32 v28, v9
    s_nop 1
    v_max_u32_dpp v28, v28, v28 quad_perm:[1,0,3,2] row_mask:0xf bank_mask:0xf
    s_nop 1
    v_max_u32_dpp v28, v28, v28 quad_perm:[2,3,0,1] row_mask:0xf bank_mask:0xf
    s_nop 1
    v_max_u32_dpp v28, v28, v28 row_half_mirror row_mask:0xf bank_mask:0xf
    s_nop 1
    v_max_u32_dpp v28, v28, v28 row_mirror row_mask:0xf bank_mask:0xf
    v_mov_b32 v29, v28
    s_nop 1
    v_permlane16_swap_b32 v28, v29
    v_max_u32 v28, v28, v29
    v_sub_u32 v9, v9, v28
    v_add_u32 v9, 15, v9
    v_max_i32 v9, 0, v9
    v_mul_u32_u24 v9, 0x10001, v9
    v_lshlrev_b32 v9, 10, v9
    v_add_lshl_u32 v28, v28, 1, 23
    v_mul_f32 v11, s55, v28
    v_mul_f32 v12, s57, v28
    v_pk_mul_f16 v32, v32, v9
    v_pk_mul_f16 v33, v33, v9
    v_pk_mul_f16 v34, v34, v9
    v_pk_mul_f16 v35, v35, v9
    v_pk_mul_f16 v36, v36, v9
    v_pk_mul_f16 v37, v37, v9
    v_pk_mul_f16 v38, v38, v9
    v_pk_mul_f16 v39, v39, v9
    v_pk_mul_f16 v40, v40, v9
    v_pk_mul_f16 v41, v41, v9
    v_pk_mul_f16 v42, v42, v9
    v_pk_mul_f16 v43, v43, v9
    v_pk_mul_f16 v44, v44, v9
    v_pk_mul_f16 v45, v45, v9
    v_pk_mul_f16 v46, v46, v9
    v_pk_mul_f16 v47, v47, v9
    v_pk_mul_f16 v48, v48, v9
    v_pk_mul_f16 v49, v49, v9
    v_pk_mul_f16 v50, v50, v9
    v_pk_mul_f16 v51, v51, v9
    v_pk_mul_f16 v52, v52, v9
    v_pk_mul_f16 v53, v53, v9
    v_pk_mul_f16 v54, v54, v9
    v_pk_mul_f16 v55, v55, v9
    v_pk_mul_f16 v56, v56, v9
    v_pk_mul_f16 v57, v57, v9
    v_pk_mul_f16 v58, v58, v9
    v_pk_mul_f16 v59, v59, v9
    v_pk_mul_f16 v60, v60, v9
    v_pk_mul_f16 v61, v61, v9
    v_pk_mul_f16 v62, v62, v9
    v_pk_mul_f16 v63, v63, v9
    s_waitcnt vmcnt(8)
    v_mfma_f32_32x32x16_f16 v[128:143], a[0:3], a[64:67], 0
    buffer_load_dwordx4 a[40:43], v96, s[36:39], s66 offen offset:2048 sc1
    v_mfma_f32_32x32x16_f16 v[128:143], a[4:7], a[68:71], v[128:143]
    v_mfma_f32_32x32x16_f16 v[128:143], a[16:19], a[72:75], v[128:143]
    buffer_load_dwordx4 a[44:47], v96, s[36:39], s66 offen offset:3072 sc1
    v_mfma_f32_32x32x16_f16 v[128:143], a[20:23], a[76:79], v[128:143]
    v_mfma_f32_32x32x16_f16 v[144:159], a[16:19], a[64:67], 0
    buffer_load_dwordx4 a[56:59], v96, s[36:39], s67 offen offset:2048 sc1
    v_mfma_f32_32x32x16_f16 v[144:159], a[20:23], a[68:71], v[144:159]
    v_mfma_f32_32x32x16_f16 v[144:159], a[0:3], a[80:83], v[144:159]
    buffer_load_dwordx4 a[60:63], v96, s[36:39], s67 offen offset:3072 sc1
    v_mfma_f32_32x32x16_f16 v[144:159], a[4:7], a[84:87], v[144:159]
    s_add_u32 m0, s60, 0
    s_waitcnt vmcnt(8)
    v_mfma_f32_32x32x16_f16 v[160:175], a[8:11], a[64:67], 0
    buffer_load_dwordx4 v17, s[36:39], 0 offen offset:0 sc1 lds
    v_mfma_f32_32x32x16_f16 v[160:175], a[12:15], a[68:71], v[160:175]
    s_nop 0
    v_cvt_pk_f16_f32 v18, v128, v129
    s_nop 4
    v_cvt_pk_f16_f32 v19, v144, v145
    v_pk_mul_f16 v80, v18, v32
    v_pk_mul_f16 v88, v19, v32
    v_pk_fma_f16 v80, v19, v40, v80
    v_pk_fma_f16 v88, v18, v40, v88 neg_lo:[1,0,0] neg_hi:[1,0,0]
    v_cvt_pk_f16_f32 v22, v130, v131
    v_mfma_f32_32x32x16_f16 v[160:175], a[24:27], a[72:75], v[160:175]
    buffer_load_dwordx4 v17, s[36:39], 0 offen offset:1024 sc1 lds
    v_cvt_pk_f16_f32 v23, v146, v147
    v_pk_mul_f16 v81, v22, v33
    v_pk_mul_f16 v89, v23, v33
    v_pk_fma_f16 v81, v23, v41, v81
    v_pk_fma_f16 v89, v22, v41, v89 neg_lo:[1,0,0] neg_hi:[1,0,0]
    v_mfma_f32_32x32x16_f16 v[160:175], a[28:31], a[76:79], v[160:175]
    v_cvt_pk_f16_f32 v18, v132, v133
    v_cvt_pk_f16_f32 v19, v148, v149
    v_pk_mul_f16 v82, v18, v34
    v_pk_mul_f16 v90, v19, v34
    v_pk_fma_f16 v82, v19, v42, v82
    v_pk_fma_f16 v90, v18, v42, v90 neg_lo:[1,0,0] neg_hi:[1,0,0]
    v_cvt_pk_f16_f32 v22, v134, v135
    v_mfma_f32_32x32x16_f16 v[176:191], a[24:27], a[64:67], 0
    buffer_load_dwordx4 v17, s[36:39], 0 offen offset:2048 sc1 lds
    v_cvt_pk_f16_f32 v23, v150, v151
    v_pk_mul_f16 v83, v22, v35
    v_pk_mul_f16 v91, v23, v35
    v_pk_fma_f16 v83, v23, v43, v83
    v_pk_fma_f16 v91, v22, v43, v91 neg_lo:[1,0,0] neg_hi:[1,0,0]
    v_mfma_f32_32x32x16_f16 v[176:191], a[28:31], a[68:71], v[176:191]
    v_cvt_pk_f16_f32 v18, v136, v137
    v_cvt_pk_f16_f32 v19, v152, v153
    v_pk_mul_f16 v84, v18, v36
    v_pk_mul_f16 v92, v19, v36
    v_pk_fma_f16 v84, v19, v44, v84
    v_pk_fma_f16 v92, v18, v44, v92 neg_lo:[1,0,0] neg_hi:[1,0,0]
    v_cvt_pk_f16_f32 v22, v138, v139
    v_mfma_f32_32x32x16_f16 v[176:191], a[8:11], a[80:83], v[176:191]
    buffer_load_dwordx4 v17, s[36:39], 0 offen offset:3072 sc1 lds
    v_cvt_pk_f16_f32 v23, v154, v155
    v_pk_mul_f16 v85, v22, v37
    v_pk_mul_f16 v93, v23, v37
    v_pk_fma_f16 v85, v23, v45, v85
    v_pk_fma_f16 v93, v22, v45, v93 neg_lo:[1,0,0] neg_hi:[1,0,0]
    v_mfma_f32_32x32x16_f16 v[176:191], a[12:15], a[84:87], v[176:191]
    s_add_u32 m0, s60, 4096
    s_waitcnt vmcnt(8)
    v_cvt_pk_f16_f32 v18, v140, v141
    v_cvt_pk_f16_f32 v19, v156, v157
    v_pk_mul_f16 v86, v18, v38
    v_pk_mul_f16 v94, v19, v38
    v_pk_fma_f16 v86, v19, v46, v86
    v_mfma_f32_32x32x16_f16 v[192:207], a[32:35], a[64:67], 0
L_padf1:
    s_cbranch_execz L_backf
    buffer_load_dwordx4 v17, s[36:39], s65 offen offset:0 sc1 lds
    v_pk_fma_f16 v94, v18, v46, v94 neg_lo:[1,0,0] neg_hi:[1,0,0]
    v_cvt_pk_f16_f32 v22, v142, v143
    v_cvt_pk_f16_f32 v23, v158, v159
    v_pk_mul_f16 v87, v22, v39
    v_pk_mul_f16 v95, v23, v39
    v_mfma_f32_32x32x16_f16 v[192:207], a[36:39], a[68:71], v[192:207]
    v_pk_fma_f16 v87, v23, v47, v87
    v_pk_fma_f16 v95, v22, v47, v95 neg_lo:[1,0,0] neg_hi:[1,0,0]
    v_cvt_pk_f16_f32 v18, v160, v161
    v_cvt_pk_f16_f32 v19, v176, v177
    v_pk_fma_f16 v64, v18, v48, v80
    v_pk_fma_f16 v72, v19, v48, v88
    v_pk_fma_f16 v64, v19, v56, v64
    v_mfma_f32_32x32x16_f16 v[192:207], a[48:51], a[72:75], v[192:207]
    buffer_load_dwordx4 v17, s[36:39], s65 offen offset:1024 sc1 lds
    v_pk_fma_f16 v72, v18, v56, v72 neg_lo:[1,0,0] neg_hi:[1,0,0]
    v_pk_fma_f16 v80, v80, s64, v64 neg_lo:[0,0,1] neg_hi:[0,0,1]
    v_pk_fma_f16 v88, v88, s64, v72 neg_lo:[0,0,1] neg_hi:[0,0,1]
    v_cvt_pk_f16_f32 v22, v162, v163
    v_cvt_pk_f16_f32 v23, v178, v179
    v_mfma_f32_32x32x16_f16 v[192:207], a[52:55], a[76:79], v[192:207]
    v_pk_fma_f16 v65, v22, v49, v81
    v_pk_fma_f16 v73, v23, v49, v89
    v_pk_fma_f16 v65, v23, v57, v65
    v_pk_fma_f16 v73, v22, v57, v73 neg_lo:[1,0,0] neg_hi:[1,0,0]
    v_pk_fma_f16 v81, v81, s64, v65 neg_lo:[0,0,1] neg_hi:[0,0,1]
    v_pk_fma_f16 v89, v89, s64, v73 neg_lo:[0,0,1] neg_hi:[0,0,1]
    v_cvt_pk_f16_f32 v18, v164, v165
    v_mfma_f32_32x32x16_f16 v[208:223], a[48:51], a[64:67], 0
    buffer_load_dwordx4 v17, s[36:39], s65 offen offset:2048 sc1 lds
    v_cvt_pk_f16_f32 v19, v180, v181
    v_pk_fma_f16 v66, v18, v50, v82
    v_pk_fma_f16 v74, v19, v50, v90
    v_pk_fma_f16 v66, v19, v58, v66
    v_pk_fma_f16 v74, v18, v58, v74 neg_lo:[1,0,0] neg_hi:[1,0,0]
    v_mfma_f32_32x32x16_f16 v[208:223], a[52:55], a[68:71], v[208:223]
    v_pk_fma_f16 v82, v82, s64, v66 neg_lo:[0,0,1] neg_hi:[0,0,1]
    v_pk_fma_f16 v90, v90, s64, v74 neg_lo:[0,0,1] neg_hi:[0,0,1]
    v_cvt_pk_f16_f32 v22, v166, v167
    v_cvt_pk_f16_f32 v23, v182, v183
    v_pk_fma_f16 v67, v22, v51, v83
    v_pk_fma_f16 v75, v23, v51, v91
    v_pk_fma_f16 v67, v23, v59, v67
    v_mfma_f32_32x32x16_f16 v[208:223], a[32:35], a[80:83], v[208:223]
    buffer_load_dwordx4 v17, s[36:39], s65 offen offset:3072 sc1 lds
    v_pk_fma_f16 v75, v22, v59, v75 neg_lo:[1,0,0] neg_hi:[1,0,0]
    v_pk_fma_f16 v83, v83, s64, v67 neg_lo:[0,0,1] neg_hi:[0,0,1]
    v_pk_fma_f16 v91, v91, s64, v75 neg_lo:[0,0,1] neg_hi:[0,0,1]
    v_cvt_pk_f16_f32 v18, v168, v169
    v_cvt_pk_f16_f32 v19, v184, v185
    v_mfma_f32_32x32x16_f16 v[208:223], a[36:39], a[84:87], v[208:223]
    s_add_u32 m0, s60, 8192
    s_waitcnt vmcnt(8)
    v_pk_fma_f16 v68, v18, v52, v84
    v_pk_fma_f16 v76, v19, v52, v92
    v_pk_fma_f16 v68, v19, v60, v68
    v_pk_fma_f16 v76, v18, v60, v76 neg_lo:[1,0,0] neg_hi:[1,0,0]
    v_pk_fma_f16 v84, v84, s64, v68 neg_lo:[0,0,1] neg_hi:[0,0,1]
    v_mfma_f32_32x32x16_f16 v[224:239], a[40:43], a[64:67], 0
    buffer_load_dwordx4 v17, s[36:39], s66 offen offset:0 sc1 lds
    v_pk_fma_f16 v92, v92, s64, v76 neg_lo:[0,0,1] neg_hi:[0,0,1]
    v_cvt_pk_f16_f32 v22, v170, v171
    v_cvt_pk_f16_f32 v23, v186, v187
    v_pk_fma_f16 v69, v22, v53, v85
    v_pk_fma_f16 v77, v23, v53, v93
    v_mfma_f32_32x32x16_f16 v[224:239], a[44:47], a[68:71], v[224:239]
    v_pk_fma_f16 v69, v23, v61, v69
    v_pk_fma_f16 v77, v22, v61, v77 neg_lo:[1,0,0] neg_hi:[1,0,0]
    v_pk_fma_f16 v85, v85, s64, v69 neg_lo:[0,0,1] neg_hi:[0,0,1]
    v_pk_fma_f16 v93, v93, s64, v77 neg_lo:[0,0,1] neg_hi:[0,0,1]
    v_cvt_pk_f16_f32 v18, v172, v173
    v_cvt_pk_f16_f32 v19, v188, v189
    v_pk_fma_f16 v70, v18, v54, v86
    v_mfma_f32_32x32x16_f16 v[224:239], a[56:59], a[72:75], v[224:239]
    buffer_load_dwordx4 v17, s[36:39], s66 offen offset:1024 sc1 lds
    v_pk_fma_f16 v78, v19, v54, v94
    v_pk_fma_f16 v70, v19, v62, v70
    v_pk_fma_f16 v78, v18, v62, v78 neg_lo:[1,0,0] neg_hi:[1,0,0]
    v_pk_fma_f16 v86, v86, s64, v70 neg_lo:[0,0,1] neg_hi:[0,0,1]
    v_pk_fma_f16 v94, v94, s64, v78 neg_lo:[0,0,1] neg_hi:[0,0,1]
    v_mfma_f32_32x32x16_f16 v[224:239], a[60:63], a[76:79], v[224:239]
    v_cvt_pk_f16_f32 v22, v174, v175
    v_cvt_pk_f16_f32 v23, v190, v191
    v_pk_fma_f16 v71, v22, v55, v87
    v_pk_fma_f16 v79, v23, v55, v95
    v_pk_fma_f16 v71, v23, v63, v71
    v_pk_fma_f16 v79, v22, v63, v79 neg_lo:[1,0,0] neg_hi:[1,0,0]
    v_pk_fma_f16 v87, v87, s64, v71 neg_lo:[0,0,1] neg_hi:[0,0,1]
    v_mfma_f32_32x32x16_f16 v[240:255], a[56:59], a[64:67], 0
    buffer_load_dwordx4 v17, s[36:39], s66 offen offset:2048 sc1 lds
    v_pk_fma_f16 v95, v95, s64, v79 neg_lo:[0,0,1] neg_hi:[0,0,1]
    v_cvt_pk_f16_f32 v18, v192, v193
    v_cvt_pk_f16_f32 v19, v208, v209
    v_pk_mul_f16 v112, v18, v32
    v_pk_mul_f16 v120, v19, v32
    v_mfma_f32_32x32x16_f16 v[240:255], a[60:63], a[68:71], v[240:255]
    v_pk_fma_f16 v112, v19, v40, v112
    v_pk_fma_f16 v120, v18, v40, v120 neg_lo:[1,0,0] neg_hi:[1,0,0]
    v_cvt_pk_f16_f32 v22, v194, v195
    v_cvt_pk_f16_f32 v23, v210, v211
    v_pk_mul_f16 v113, v22, v33
    v_pk_mul_f16 v121, v23, v33
    v_pk_fma_f16 v113, v23, v41, v113
    v_mfma_f32_32x32x16_f16 v[240:255], a[40:43], a[80:83], v[240:255]
    buffer_load_dwordx4 v17, s[36:39], s66 offen offset:3072 sc1 lds
    v_pk_fma_f16 v121, v22, v41, v121 neg_lo:[1,0,0] neg_hi:[1,0,0]
    v_cvt_pk_f16_f32 v18, v196, v197
    v_cvt_pk_f16_f32 v19, v212, v213
    v_pk_mul_f16 v114, v18, v34
    v_pk_mul_f16 v122, v19, v34
    v_mfma_f32_32x32x16_f16 v[240:255], a[44:47], a[84:87], v[240:255]
    s_add_u32 m0, s60, 12288
    v_pk_fma_f16 v114, v19, v42, v114
    v_pk_fma_f16 v122, v18, v42, v122 neg_lo:[1,0,0] neg_hi:[1,0,0]
    v_cvt_pk_f16_f32 v22, v198, v199
    v_cvt_pk_f16_f32 v23, v214, v215
    v_pk_mul_f16 v115, v22, v35
    v_pk_mul_f16 v123, v23, v35
    v_mfma_f32_32x32x16_f16 v[128:143], a[64:67], v[64:67], 0
    buffer_load_dwordx4 v17, s[36:39], s67 offen offset:0 sc1 lds
    v_pk_fma_f16 v115, v23, v43, v115
    v_pk_fma_f16 v123, v22, v43, v123 neg_lo:[1,0,0] neg_hi:[1,0,0]
    v_cvt_pk_f16_f32 v18, v200, v201
    v_cvt_pk_f16_f32 v19, v216, v217
    v_pk_mul_f16 v116, v18, v36
    v_mfma_f32_32x32x16_f16 v[128:143], a[68:71], v[68:71], v[128:143]
    v_pk_mul_f16 v124, v19, v36
    v_pk_fma_f16 v116, v19, v44, v116
    v_pk_fma_f16 v124, v18, v44, v124 neg_lo:[1,0,0] neg_hi:[1,0,0]
    v_cvt_pk_f16_f32 v22, v202, v203
    v_cvt_pk_f16_f32 v23, v218, v219
    v_pk_mul_f16 v117, v22, v37
    v_pk_mul_f16 v125, v23, v37
    v_mfma_f32_32x32x16_f16 v[128:143], a[72:75], v[72:75], v[128:143]
    buffer_load_dwordx4 v17, s[36:39], s67 offen offset:1024 sc1 lds
    v_pk_fma_f16 v117, v23, v45, v117
    v_pk_fma_f16 v125, v22, v45, v125 neg_lo:[1,0,0] neg_hi:[1,0,0]
    v_cvt_pk_f16_f32 v18, v204, v205
    v_cvt_pk_f16_f32 v19, v220, v221
    v_pk_mul_f16 v118, v18, v38
    v_mfma_f32_32x32x16_f16 v[128:143], a[76:79], v[76:79], v[128:143]
    v_pk_mul_f16 v126, v19, v38
    v_pk_fma_f16 v118, v19, v46, v118
    v_pk_fma_f16 v126, v18, v46, v126 neg_lo:[1,0,0] neg_hi:[1,0,0]
    v_cvt_pk_f16_f32 v22, v206, v207
    v_cvt_pk_f16_f32 v23, v222, v223
    v_pk_mul_f16 v119, v22, v39
    v_pk_mul_f16 v127, v23, v39
    v_mfma_f32_32x32x16_f16 v[144:159], a[64:67], v[72:75], 0
    buffer_load_dwordx4 v17, s[36:39], s67 offen offset:2048 sc1 lds
    v_pk_fma_f16 v119, v23, v47, v119
    v_pk_fma_f16 v127, v22, v47, v127 neg_lo:[1,0,0] neg_hi:[1,0,0]
    v_cvt_pk_f16_f32 v18, v224, v225
    v_cvt_pk_f16_f32 v19, v240, v241
    v_pk_fma_f16 v96, v18, v48, v112
    v_mfma_f32_32x32x16_f16 v[144:159], a[68:71], v[76:79], v[144:159]
    v_pk_fma_f16 v104, v19, v48, v120
    v_pk_fma_f16 v96, v19, v56, v96
    v_pk_fma_f16 v104, v18, v56, v104 neg_lo:[1,0,0] neg_hi:[1,0,0]
    v_pk_fma_f16 v112, v112, s64, v96 neg_lo:[0,0,1] neg_hi:[0,0,1]
    v_pk_fma_f16 v120, v120, s64, v104 neg_lo:[0,0,1] neg_hi:[0,0,1]
    v_cvt_pk_f16_f32 v22, v226, v227
    v_cvt_pk_f16_f32 v23, v242, v243
    v_mfma_f32_32x32x16_f16 v[144:159], a[80:83], v[64:67], v[144:159]
    buffer_load_dwordx4 v17, s[36:39], s67 offen offset:3072 sc1 lds
    v_pk_fma_f16 v97, v22, v49, v113
    v_pk_fma_f16 v105, v23, v49, v121
    v_pk_fma_f16 v97, v23, v57, v97
    v_pk_fma_f16 v105, v22, v57, v105 neg_lo:[1,0,0] neg_hi:[1,0,0]
    v_pk_fma_f16 v113, v113, s64, v97 neg_lo:[0,0,1] neg_hi:[0,0,1]
    v_mfma_f32_32x32x16_f16 v[144:159], a[84:87], v[68:71], v[144:159]
    v_pk_fma_f16 v121, v121, s64, v105 neg_lo:[0,0,1] neg_hi:[0,0,1]
    v_cvt_pk_f16_f32 v18, v228, v229
    v_cvt_pk_f16_f32 v19, v244, v245
    v_pk_fma_f16 v98, v18, v50, v114
    v_pk_fma_f16 v106, v19, v50, v122
    v_pk_fma_f16 v98, v19, v58, v98
    v_pk_fma_f16 v106, v18, v58, v106 neg_lo:[1,0,0] neg_hi:[1,0,0]
    v_mfma_f32_32x32x16_f16 v[160:175], a[88:91], v[80:83], 0
    v_pk_fma_f16 v114, v114, s64, v98 neg_lo:[0,0,1] neg_hi:[0,0,1]
    v_pk_fma_f16 v122, v122, s64, v106 neg_lo:[0,0,1] neg_hi:[0,0,1]
    v_cvt_pk_f16_f32 v22, v230, v231
    v_cvt_pk_f16_f32 v23, v246, v247
    v_pk_fma_f16 v99, v22, v51, v115
    v_pk_fma_f16 v107, v23, v51, v123
    v_pk_fma_f16 v99, v23, v59, v99
    v_mfma_f32_32x32x16_f16 v[160:175], a[92:95], v[84:87], v[160:175]
    v_pk_fma_f16 v107, v22, v59, v107 neg_lo:[1,0,0] neg_hi:[1,0,0]
    v_pk_fma_f16 v115, v115, s64, v99 neg_lo:[0,0,1] neg_hi:[0,0,1]
    v_pk_fma_f16 v123, v123, s64, v107 neg_lo:[0,0,1] neg_hi:[0,0,1]
    v_cvt_pk_f16_f32 v18, v232, v233
    v_cvt_pk_f16_f32 v19, v248, v249
    v_pk_fma_f16 v100, v18, v52, v116
    v_pk_fma_f16 v108, v19, v52, v124
    v_mfma_f32_32x32x16_f16 v[160:175], a[96:99], v[88:91], v[160:175]
    v_pk_fma_f16 v100, v19, v60, v100
    v_pk_fma_f16 v108, v18, v60, v108 neg_lo:[1,0,0] neg_hi:[1,0,0]
    v_pk_fma_f16 v116, v116, s64, v100 neg_lo:[0,0,1] neg_hi:[0,0,1]
    v_pk_fma_f16 v124, v124, s64, v108 neg_lo:[0,0,1] neg_hi:[0,0,1]
    v_cvt_pk_f16_f32 v22, v234, v235
    v_cvt_pk_f16_f32 v23, v250, v251
    v_pk_fma_f16 v101, v22, v53, v117
    v_mfma_f32_32x32x16_f16 v[160:175], a[100:103], v[92:95], v[160:175]
    v_pk_fma_f16 v109, v23, v53, v125
    v_pk_fma_f16 v101, v23, v61, v101
    v_pk_fma_f16 v109, v22, v61, v109 neg_lo:[1,0,0] neg_hi:[1,0,0]
    v_pk_fma_f16 v117, v117, s64, v101 neg_lo:[0,0,1] neg_hi:[0,0,1]
    v_pk_fma_f16 v125, v125, s64, v109 neg_lo:[0,0,1] neg_hi:[0,0,1]
    v_cvt_pk_f16_f32 v18, v236, v237
    v_cvt_pk_f16_f32 v19, v252, v253
    v_mfma_f32_32x32x16_f16 v[176:191], a[88:91], v[88:91], 0
    v_pk_fma_f16 v102, v18, v54, v118
    v_pk_fma_f16 v110, v19, v54, v126
    v_pk_fma_f16 v102, v19, v62, v102
    v_pk_fma_f16 v110, v18, v62, v110 neg_lo:[1,0,0] neg_hi:[1,0,0]
    v_pk_fma_f16 v118, v118, s64, v102 neg_lo:[0,0,1] neg_hi:[0,0,1]
    v_pk_fma_f16 v126, v126, s64, v110 neg_lo:[0,0,1] neg_hi:[0,0,1]
    v_cvt_pk_f16_f32 v22, v238, v239
    v_mfma_f32_32x32x16_f16 v[176:191], a[92:95], v[92:95], v[176:191]
    v_cvt_pk_f16_f32 v23, v254, v255
    v_pk_fma_f16 v103, v22, v55, v119
    v_pk_fma_f16 v111, v23, v55, v127
    v_pk_fma_f16 v103, v23, v63, v103
    v_pk_fma_f16 v111, v22, v63, v111 neg_lo:[1,0,0] neg_hi:[1,0,0]
    v_pk_fma_f16 v119, v119, s64, v103 neg_lo:[0,0,1] neg_hi:[0,0,1]
    v_pk_fma_f16 v127, v127, s64, v111 neg_lo:[0,0,1] neg_hi:[0,0,1]
    v_mfma_f32_32x32x16_f16 v[176:191], a[104:107], v[80:83], v[176:191]
    s_waitcnt vmcnt(0)
    s_barrier
    ds_read_b128 v[32:35], v13 offset:0
    ds_read_b128 v[36:39], v13 offset:16384
    ds_read_b128 v[40:43], v13 offset:8192
    ds_read_b128 v[44:47], v13 offset:24576
    v_mfma_f32_32x32x16_f16 v[176:191], a[108:111], v[84:87], v[176:191]
    v_mfma_f32_32x32x16_f16 v[192:207], a[64:67], v[96:99], 0
    ds_read_b128 v[48:51], v13 offset:32768
    ds_read_b128 v[52:55], v13 offset:49152
    ds_read_b128 v[56:59], v13 offset:40960
    ds_read_b128 v[60:63], v13 offset:57344
    s_waitcnt lgkmcnt(4)
    v_cvt_pk_f16_f32 v18, v128, v129
    v_mfma_f32_32x32x16_f16 v[192:207], a[68:71], v[100:103], v[192:207]
    v_cvt_pk_f16_f32 v19, v144, v145
    v_pk_mul_f16 v64, v18, v32
    v_pk_mul_f16 v72, v19, v32
    v_pk_fma_f16 v64, v19, v40, v64 neg_lo:[1,0,0] neg_hi:[1,0,0]
    v_pk_fma_f16 v72, v18, v40, v72
    v_cvt_pk_f16_f32 v22, v130, v131
    v_mfma_f32_32x32x16_f16 v[192:207], a[72:75], v[104:107], v[192:207]
    v_cvt_pk_f16_f32 v23, v146, v147
    v_pk_mul_f16 v65, v22, v33
    v_pk_mul_f16 v73, v23, v33
    v_pk_fma_f16 v65, v23, v41, v65 neg_lo:[1,0,0] neg_hi:[1,0,0]
    v_pk_fma_f16 v73, v22, v41, v73
    v_cvt_pk_f16_f32 v18, v132, v133
    v_mfma_f32_32x32x16_f16 v[192:207], a[76:79], v[108:111], v[192:207]
    v_cvt_pk_f16_f32 v19, v148, v149
    v_pk_mul_f16 v66, v18, v34
    v_pk_mul_f16 v74, v19, v34
    v_pk_fma_f16 v66, v19, v42, v66 neg_lo:[1,0,0] neg_hi:[1,0,0]
    v_pk_fma_f16 v74, v18, v42, v74
    v_cvt_pk_f16_f32 v22, v134, v135
    v_mfma_f32_32x32x16_f16 v[208:223], a[64:67], v[104:107], 0
    v_cvt_pk_f16_f32 v23, v150, v151
    v_pk_mul_f16 v67, v22, v35
    v_pk_mul_f16 v75, v23, v35
    v_pk_fma_f16 v67, v23, v43, v67 neg_lo:[1,0,0] neg_hi:[1,0,0]
    v_pk_fma_f16 v75, v22, v43, v75
    v_cvt_pk_f16_f32 v18, v136, v137
    v_mfma_f32_32x32x16_f16 v[208:223], a[68:71], v[108:111], v[208:223]
    v_cvt_pk_f16_f32 v19, v152, v153
    v_pk_mul_f16 v68, v18, v36
    v_pk_mul_f16 v76, v19, v36
    v_pk_fma_f16 v68, v19, v44, v68 neg_lo:[1,0,0] neg_hi:[1,0,0]
    v_pk_fma_f16 v76, v18, v44, v76
    v_cvt_pk_f16_f32 v22, v138, v139
    v_mfma_f32_32x32x16_f16 v[208:223], a[80:83], v[96:99], v[208:223]
    ds_read_b128 v[32:35], v14 offset:0
    v_cvt_pk_f16_f32 v23, v154, v155
    v_pk_mul_f16 v69, v22, v37
    v_pk_mul_f16 v77, v23, v37
    v_pk_fma_f16 v69, v23, v45, v69 neg_lo:[1,0,0] neg_hi:[1,0,0]
    v_pk_fma_f16 v77, v22, v45, v77
    v_mfma_f32_32x32x16_f16 v[208:223], a[84:87], v[100:103], v[208:223]
    v_cvt_pk_f16_f32 v18, v140, v141
    v_cvt_pk_f16_f32 v19, v156, v157
    v_pk_mul_f16 v70, v18, v38
    v_pk_mul_f16 v78, v19, v38
    v_pk_fma_f16 v70, v19, v46, v70 neg_lo:[1,0,0] neg_hi:[1,0,0]
    v_pk_fma_f16 v78, v18, v46, v78
    v_mfma_f32_32x32x16_f16 v[224:239], a[88:91], v[112:115], 0
    v_cvt_pk_f16_f32 v22, v142, v143
    v_cvt_pk_f16_f32 v23, v158, v159
    v_pk_mul_f16 v71, v22, v39
    v_pk_mul_f16 v79, v23, v39
    v_pk_fma_f16 v71, v23, v47, v71 neg_lo:[1,0,0] neg_hi:[1,0,0]
    v_pk_fma_f16 v79, v22, v47, v79
    v_mfma_f32_32x32x16_f16 v[224:239], a[92:95], v[116:119], v[224:239]
    ds_read_b128 v[36:39], v14 offset:16384
    ds_read_b128 v[40:43], v14 offset:8192
    ds_read_b128 v[44:47], v14 offset:24576
    s_waitcnt lgkmcnt(4)
    v_cvt_pk_f16_f32 v18, v160, v161
    v_cvt_pk_f16_f32 v19, v176, v177
    v_mfma_f32_32x32x16_f16 v[224:239], a[96:99], v[120:123], v[224:239]
    v_pk_mul_f16 v80, v18, v48
    v_pk_mul_f16 v88, v19, v48
    v_pk_fma_f16 v80, v19, v56, v80 neg_lo:[1,0,0] neg_hi:[1,0,0]
    v_pk_fma_f16 v88, v18, v56, v88
    v_cvt_pk_f16_f32 v22, v162, v163
    v_cvt_pk_f16_f32 v23, v178, v179
    v_mfma_f32_32x32x16_f16 v[224:239], a[100:103], v[124:127], v[224:239]
    v_pk_mul_f16 v81, v22, v49
    v_pk_mul_f16 v89, v23, v49
    v_pk_fma_f16 v81, v23, v57, v81 neg_lo:[1,0,0] neg_hi:[1,0,0]
    v_pk_fma_f16 v89, v22, v57, v89
    v_cvt_pk_f16_f32 v18, v164, v165
    v_cvt_pk_f16_f32 v19, v180, v181
    v_mfma_f32_32x32x16_f16 v[240:255], a[88:91], v[120:123], 0
    v_pk_mul_f16 v82, v18, v50
    v_pk_mul_f16 v90, v19, v50
    v_pk_fma_f16 v82, v19, v58, v82 neg_lo:[1,0,0] neg_hi:[1,0,0]
    v_pk_fma_f16 v90, v18, v58, v90
    v_cvt_pk_f16_f32 v22, v166, v167
    v_cvt_pk_f16_f32 v23, v182, v183
    v_mfma_f32_32x32x16_f16 v[240:255], a[92:95], v[124:127], v[240:255]
    v_pk_mul_f16 v83, v22, v51
    v_pk_mul_f16 v91, v23, v51
    v_pk_fma_f16 v83, v23, v59, v83 neg_lo:[1,0,0] neg_hi:[1,0,0]
    v_pk_fma_f16 v91, v22, v59, v91
    v_cvt_pk_f16_f32 v18, v168, v169
    v_cvt_pk_f16_f32 v19, v184, v185
    v_mfma_f32_32x32x16_f16 v[240:255], a[104:107], v[112:115], v[240:255]
    v_pk_mul_f16 v84, v18, v52
    v_pk_mul_f16 v92, v19, v52
    v_pk_fma_f16 v84, v19, v60, v84 neg_lo:[1,0,0] neg_hi:[1,0,0]
    v_pk_fma_f16 v92, v18, v60, v92
    v_cvt_pk_f16_f32 v22, v170, v171
    v_cvt_pk_f16_f32 v23, v186, v187
    v_mfma_f32_32x32x16_f16 v[240:255], a[108:111], v[116:119], v[240:255]
    ds_read_b128 v[48:51], v14 offset:32768
    v_pk_mul_f16 v85, v22, v53
    v_pk_mul_f16 v93, v23, v53
    v_pk_fma_f16 v85, v23, v61, v85 neg_lo:[1,0,0] neg_hi:[1,0,0]
    v_pk_fma_f16 v93, v22, v61, v93
    v_cvt_pk_f16_f32 v18, v172, v173
    v_mfma_f32_32x32x16_f16 v[128:143], v[64:67], a[64:67], 0
    v_cvt_pk_f16_f32 v19, v188, v189
    v_pk_mul_f16 v86, v18, v54
    v_pk_mul_f16 v94, v19, v54
    v_pk_fma_f16 v86, v19, v62, v86 neg_lo:[1,0,0] neg_hi:[1,0,0]
    v_pk_fma_f16 v94, v18, v62, v94
    v_cvt_pk_f16_f32 v22, v174, v175
    v_mfma_f32_32x32x16_f16 v[128:143], v[68:71], a[68:71], v[128:143]
    v_cvt_pk_f16_f32 v23, v190, v191
    v_pk_mul_f16 v87, v22, v55
    v_pk_mul_f16 v95, v23, v55
    v_pk_fma_f16 v87, v23, v63, v87 neg_lo:[1,0,0] neg_hi:[1,0,0]
    v_pk_fma_f16 v95, v22, v63, v95
    v_mfma_f32_32x32x16_f16 v[128:143], v[72:75], a[80:83], v[128:143]
    ds_read_b128 v[52:55], v14 offset:49152
    ds_read_b128 v[56:59], v14 offset:40960
    ds_read_b128 v[60:63], v14 offset:57344
    s_waitcnt lgkmcnt(4)
    v_cvt_pk_f16_f32 v18, v192, v193
    v_cvt_pk_f16_f32 v19, v208, v209
    v_mfma_f32_32x32x16_f16 v[128:143], v[76:79], a[84:87], v[128:143]
    v_pk_mul_f16 v96, v18, v32
    v_pk_mul_f16 v104, v19, v32
    v_pk_fma_f16 v96, v19, v40, v96 neg_lo:[1,0,0] neg_hi:[1,0,0]
    v_pk_fma_f16 v104, v18, v40, v104
    v_cvt_pk_f16_f32 v22, v194, v195
    v_cvt_pk_f16_f32 v23, v210, v211
    v_mfma_f32_32x32x16_f16 v[144:159], v[72:75], a[64:67], 0
    v_pk_mul_f16 v97, v22, v33
    v_pk_mul_f16 v105, v23, v33
    v_pk_fma_f16 v97, v23, v41, v97 neg_lo:[1,0,0] neg_hi:[1,0,0]
    v_pk_fma_f16 v105, v22, v41, v105
    v_cvt_pk_f16_f32 v18, v196, v197
    v_cvt_pk_f16_f32 v19, v212, v213
    v_mfma_f32_32x32x16_f16 v[144:159], v[76:79], a[68:71], v[144:159]
    v_pk_mul_f16 v98, v18, v34
    v_pk_mul_f16 v106, v19, v34
    v_pk_fma_f16 v98, v19, v42, v98 neg_lo:[1,0,0] neg_hi:[1,0,0]
    v_pk_fma_f16 v106, v18, v42, v106
    v_cvt_pk_f16_f32 v22, v198, v199
    v_cvt_pk_f16_f32 v23, v214, v215
    v_mfma_f32_32x32x16_f16 v[144:159], v[64:67], a[72:75], v[144:159]
    v_pk_mul_f16 v99, v22, v35
    v_pk_mul_f16 v107, v23, v35
    v_pk_fma_f16 v99, v23, v43, v99 neg_lo:[1,0,0] neg_hi:[1,0,0]
    v_pk_fma_f16 v107, v22, v43, v107
    v_cvt_pk_f16_f32 v18, v200, v201
    v_cvt_pk_f16_f32 v19, v216, v217
    v_mfma_f32_32x32x16_f16 v[144:159], v[68:71], a[76:79], v[144:159]
    v_pk_mul_f16 v100, v18, v36
    v_pk_mul_f16 v108, v19, v36
    v_pk_fma_f16 v100, v19, v44, v100 neg_lo:[1,0,0] neg_hi:[1,0,0]
    v_pk_fma_f16 v108, v18, v44, v108
    v_cvt_pk_f16_f32 v22, v202, v203
    v_cvt_pk_f16_f32 v23, v218, v219
    v_mfma_f32_32x32x16_f16 v[160:175], v[80:83], a[112:115], v[128:143]
    ds_read_b128 v[32:35], v4 offset:0
    v_pk_mul_f16 v101, v22, v37
    v_pk_mul_f16 v109, v23, v37
    v_pk_fma_f16 v101, v23, v45, v101 neg_lo:[1,0,0] neg_hi:[1,0,0]
    v_pk_fma_f16 v109, v22, v45, v109
    v_cvt_pk_f16_f32 v18, v204, v205
    v_mfma_f32_32x32x16_f16 v[160:175], v[84:87], a[116:119], v[160:175]
    v_cvt_pk_f16_f32 v19, v220, v221
    v_pk_mul_f16 v102, v18, v38
    v_pk_mul_f16 v110, v19, v38
    v_pk_fma_f16 v102, v19, v46, v102 neg_lo:[1,0,0] neg_hi:[1,0,0]
    v_pk_fma_f16 v110, v18, v46, v110
    v_cvt_pk_f16_f32 v22, v206, v207
    v_mfma_f32_32x32x16_f16 v[160:175], v[88:91], a[128:131], v[160:175]
    v_cvt_pk_f16_f32 v23, v222, v223
    v_pk_mul_f16 v103, v22, v39
    v_pk_mul_f16 v111, v23, v39
    v_pk_fma_f16 v103, v23, v47, v103 neg_lo:[1,0,0] neg_hi:[1,0,0]
    v_pk_fma_f16 v111, v22, v47, v111
    v_mfma_f32_32x32x16_f16 v[160:175], v[92:95], a[132:135], v[160:175]
    ds_read_b128 v[36:39], v4 offset:1024
    ds_read_b128 v[40:43], v4 offset:2048
    ds_read_b128 v[44:47], v4 offset:3072
    s_waitcnt lgkmcnt(4)
    v_cvt_pk_f16_f32 v18, v224, v225
    v_cvt_pk_f16_f32 v19, v240, v241
    v_mfma_f32_32x32x16_f16 v[176:191], v[88:91], a[112:115], v[144:159]
    v_pk_mul_f16 v112, v18, v48
    v_pk_mul_f16 v120, v19, v48
    v_pk_fma_f16 v112, v19, v56, v112 neg_lo:[1,0,0] neg_hi:[1,0,0]
    v_pk_fma_f16 v120, v18, v56, v120
    v_cvt_pk_f16_f32 v22, v226, v227
    v_cvt_pk_f16_f32 v23, v242, v243
    v_mfma_f32_32x32x16_f16 v[176:191], v[92:95], a[116:119], v[176:191]
    v_pk_mul_f16 v113, v22, v49
    v_pk_mul_f16 v121, v23, v49
    v_pk_fma_f16 v113, v23, v57, v113 neg_lo:[1,0,0] neg_hi:[1,0,0]
    v_pk_fma_f16 v121, v22, v57, v121
    v_cvt_pk_f16_f32 v18, v228, v229
    v_cvt_pk_f16_f32 v19, v244, v245
    v_mfma_f32_32x32x16_f16 v[176:191], v[80:83], a[120:123], v[176:191]
    v_pk_mul_f16 v114, v18, v50
    v_pk_mul_f16 v122, v19, v50
    v_pk_fma_f16 v114, v19, v58, v114 neg_lo:[1,0,0] neg_hi:[1,0,0]
    v_pk_fma_f16 v122, v18, v58, v122
    v_cvt_pk_f16_f32 v22, v230, v231
    v_cvt_pk_f16_f32 v23, v246, v247
    v_mfma_f32_32x32x16_f16 v[176:191], v[84:87], a[124:127], v[176:191]
    v_pk_mul_f16 v115, v22, v51
    v_pk_mul_f16 v123, v23, v51
    v_pk_fma_f16 v115, v23, v59, v115 neg_lo:[1,0,0] neg_hi:[1,0,0]
    v_pk_fma_f16 v123, v22, v59, v123
    v_cvt_pk_f16_f32 v18, v232, v233
    v_cvt_pk_f16_f32 v19, v248, v249
    v_mfma_f32_32x32x16_f16 v[192:207], v[96:99], a[64:67], 0
    v_pk_mul_f16 v116, v18, v52
    v_pk_mul_f16 v124, v19, v52
    v_pk_fma_f16 v116, v19, v60, v116 neg_lo:[1,0,0] neg_hi:[1,0,0]
    v_pk_fma_f16 v124, v18, v60, v124
    v_cvt_pk_f16_f32 v22, v234, v235
    v_cvt_pk_f16_f32 v23, v250, v251
    v_mfma_f32_32x32x16_f16 v[192:207], v[100:103], a[68:71], v[192:207]
    ds_read_b128 v[48:51], v4 offset:4096
    v_pk_mul_f16 v117, v22, v53
    v_pk_mul_f16 v125, v23, v53
    v_pk_fma_f16 v117, v23, v61, v117 neg_lo:[1,0,0] neg_hi:[1,0,0]
    v_pk_fma_f16 v125, v22, v61, v125
    v_cvt_pk_f16_f32 v18, v236, v237
    v_cvt_pk_f16_f32 v19, v252, v253
    v_mfma_f32_32x32x16_f16 v[192:207], v[104:107], a[80:83], v[192:207]
    v_pk_mul_f16 v118, v18, v54
    v_pk_mul_f16 v126, v19, v54
    v_pk_fma_f16 v118, v19, v62, v118 neg_lo:[1,0,0] neg_hi:[1,0,0]
    v_pk_fma_f16 v126, v18, v62, v126
    v_cvt_pk_f16_f32 v22, v238, v239
    v_cvt_pk_f16_f32 v23, v254, v255
    v_pk_mul_f16 v119, v22, v55
    v_mfma_f32_32x32x16_f16 v[192:207], v[108:111], a[84:87], v[192:207]
    v_pk_mul_f16 v127, v23, v55
    v_pk_fma_f16 v119, v23, v63, v119 neg_lo:[1,0,0] neg_hi:[1,0,0]
    v_pk_fma_f16 v127, v22, v63, v127
    v_mfma_f32_32x32x16_f16 v[208:223], v[104:107], a[64:67], 0
    ds_read_b128 v[52:55], v4 offset:5120
    ds_read_b128 v[56:59], v4 offset:6144
    ds_read_b128 v[60:63], v4 offset:7168
    v_cvt_pk_f16_f32 v64, v128, v129
    v_cvt_pk_f16_f32 v72, v144, v145
    v_cvt_pk_f16_f32 v65, v130, v131
    v_cvt_pk_f16_f32 v73, v146, v147
    v_mfma_f32_32x32x16_f16 v[208:223], v[108:111], a[68:71], v[208:223]
    v_cvt_pk_f16_f32 v66, v132, v133
    v_cvt_pk_f16_f32 v74, v148, v149
    v_cvt_pk_f16_f32 v67, v134, v135
    v_cvt_pk_f16_f32 v75, v150, v151
    v_cvt_pk_f16_f32 v68, v136, v137
    v_cvt_pk_f16_f32 v76, v152, v153
    v_cvt_pk_f16_f32 v69, v138, v139
    v_mfma_f32_32x32x16_f16 v[208:223], v[96:99], a[72:75], v[208:223]
    v_cvt_pk_f16_f32 v77, v154, v155
    v_cvt_pk_f16_f32 v70, v140, v141
    v_cvt_pk_f16_f32 v78, v156, v157
    v_cvt_pk_f16_f32 v71, v142, v143
    v_cvt_pk_f16_f32 v79, v158, v159
    v_mfma_f32_32x32x16_f16 v[208:223], v[100:103], a[76:79], v[208:223]
    s_waitcnt lgkmcnt(0)
    v_cvt_pk_f16_f32 v18, v160, v161
    v_cvt_pk_f16_f32 v19, v176, v177
    v_pk_fma_f16 v20, v64, s64, v18 neg_lo:[0,0,1] neg_hi:[0,0,1]
    v_pk_fma_f16 v21, v72, s64, v19 neg_lo:[0,0,1] neg_hi:[0,0,1]
    v_pk_mul_f16 v64, v18, v32
    v_pk_mul_f16 v72, v19, v32
    v_mfma_f32_32x32x16_f16 v[224:239], v[112:115], a[112:115], v[192:207]
L_padf2:
    s_cbranch_execz L_backf
    v_pk_mul_f16 v80, v20, v48
    v_pk_mul_f16 v88, v21, v48
    v_pk_fma_f16 v64, v19, v40, v64 neg_lo:[1,0,0] neg_hi:[1,0,0]
    v_pk_fma_f16 v72, v18, v40, v72
    v_pk_fma_f16 v80, v21, v56, v80 neg_lo:[1,0,0] neg_hi:[1,0,0]
    v_pk_fma_f16 v88, v20, v56, v88
    v_cvt_pk_f16_f32 v22, v162, v163
    v_mfma_f32_32x32x16_f16 v[224:239], v[116:119], a[116:119], v[224:239]
    v_cvt_pk_f16_f32 v23, v178, v179
    v_pk_fma_f16 v24, v65, s64, v22 neg_lo:[0,0,1] neg_hi:[0,0,1]
    v_pk_fma_f16 v25, v73, s64, v23 neg_lo:[0,0,1] neg_hi:[0,0,1]
    v_pk_mul_f16 v65, v22, v33
    v_pk_mul_f16 v73, v23, v33
    v_pk_mul_f16 v81, v24, v49
    v_pk_mul_f16 v89, v25, v49
    v_mfma_f32_32x32x16_f16 v[224:239], v[120:123], a[128:131], v[224:239]
    v_pk_fma_f16 v65, v23, v41, v65 neg_lo:[1,0,0] neg_hi:[1,0,0]
    v_pk_fma_f16 v73, v22, v41, v73
    v_pk_fma_f16 v81, v25, v57, v81 neg_lo:[1,0,0] neg_hi:[1,0,0]
    v_pk_fma_f16 v89, v24, v57, v89
    v_cvt_pk_f16_f32 v18, v164, v165
    v_cvt_pk_f16_f32 v19, v180, v181
    v_pk_fma_f16 v20, v66, s64, v18 neg_lo:[0,0,1] neg_hi:[0,0,1]
    v_mfma_f32_32x32x16_f16 v[224:239], v[124:127], a[132:135], v[224:239]
    v_pk_fma_f16 v21, v74, s64, v19 neg_lo:[0,0,1] neg_hi:[0,0,1]
    v_pk_mul_f16 v66, v18, v34
    v_pk_mul_f16 v74, v19, v34
    v_pk_mul_f16 v82, v20, v50
    v_pk_mul_f16 v90, v21, v50
    v_pk_fma_f16 v66, v19, v42, v66 neg_lo:[1,0,0] neg_hi:[1,0,0]
    v_pk_fma_f16 v74, v18, v42, v74
    v_mfma_f32_32x32x16_f16 v[240:255], v[120:123], a[112:115], v[208:223]
    v_pk_fma_f16 v82, v21, v58, v82 neg_lo:[1,0,0] neg_hi:[1,0,0]
    v_pk_fma_f16 v90, v20, v58, v90
    v_cvt_pk_f16_f32 v22, v166, v167
    v_cvt_pk_f16_f32 v23, v182, v183
    v_pk_fma_f16 v24, v67, s64, v22 neg_lo:[0,0,1] neg_hi:[0,0,1]
    v_pk_fma_f16 v25, v75, s64, v23 neg_lo:[0,0,1] neg_hi:[0,0,1]
    v_pk_mul_f16 v67, v22, v35
    v_mfma_f32_32x32x16_f16 v[240:255], v[124:127], a[116:119], v[240:255]
    v_pk_mul_f16 v75, v23, v35
    v_pk_mul_f16 v83, v24, v51
    v_pk_mul_f16 v91, v25, v51
    v_pk_fma_f16 v67, v23, v43, v67 neg_lo:[1,0,0] neg_hi:[1,0,0]
    v_pk_fma_f16 v75, v22, v43, v75
    v_pk_fma_f16 v83, v25, v59, v83 neg_lo:[1,0,0] neg_hi:[1,0,0]
    v_pk_fma_f16 v91, v24, v59, v91
    v_mfma_f32_32x32x16_f16 v[240:255], v[112:115], a[120:123], v[240:255]
    v_cvt_pk_f16_f32 v18, v168, v169
    v_cvt_pk_f16_f32 v19, v184, v185
    v_pk_fma_f16 v20, v68, s64, v18 neg_lo:[0,0,1] neg_hi:[0,0,1]
    v_pk_fma_f16 v21, v76, s64, v19 neg_lo:[0,0,1] neg_hi:[0,0,1]
    v_pk_mul_f16 v68, v18, v36
    v_pk_mul_f16 v76, v19, v36
    v_pk_mul_f16 v84, v20, v52
    v_mfma_f32_32x32x16_f16 v[240:255], v[116:119], a[124:127], v[240:255]
    v_pk_mul_f16 v92, v21, v52
    v_pk_fma_f16 v68, v19, v44, v68 neg_lo:[1,0,0] neg_hi:[1,0,0]
    v_pk_fma_f16 v76, v18, v44, v76
    v_pk_fma_f16 v84, v21, v60, v84 neg_lo:[1,0,0] neg_hi:[1,0,0]
    v_pk_fma_f16 v92, v20, v60, v92
    v_cvt_pk_f16_f32 v22, v170, v171
    v_cvt_pk_f16_f32 v23, v186, v187
    v_pk_fma_f16 v24, v69, s64, v22 neg_lo:[0,0,1] neg_hi:[0,0,1]
    v_pk_fma_f16 v25, v77, s64, v23 neg_lo:[0,0,1] neg_hi:[0,0,1]
    v_pk_mul_f16 v69, v22, v37
    v_pk_mul_f16 v77, v23, v37
    v_pk_mul_f16 v85, v24, v53
    v_pk_mul_f16 v93, v25, v53
    v_pk_fma_f16 v69, v23, v45, v69 neg_lo:[1,0,0] neg_hi:[1,0,0]
    v_pk_fma_f16 v77, v22, v45, v77
    v_pk_fma_f16 v85, v25, v61, v85 neg_lo:[1,0,0] neg_hi:[1,0,0]
    v_pk_fma_f16 v93, v24, v61, v93
    v_cvt_pk_f16_f32 v18, v172, v173
    v_cvt_pk_f16_f32 v19, v188, v189
    v_pk_fma_f16 v20, v70, s64, v18 neg_lo:[0,0,1] neg_hi:[0,0,1]
    v_pk_fma_f16 v21, v78, s64, v19 neg_lo:[0,0,1] neg_hi:[0,0,1]
    v_pk_mul_f16 v70, v18, v38
    v_pk_mul_f16 v78, v19, v38
    v_pk_mul_f16 v86, v20, v54
    v_pk_mul_f16 v94, v21, v54
    v_pk_fma_f16 v70, v19, v46, v70 neg_lo:[1,0,0] neg_hi:[1,0,0]
    v_pk_fma_f16 v78, v18, v46, v78
    v_pk_fma_f16 v86, v21, v62, v86 neg_lo:[1,0,0] neg_hi:[1,0,0]
    v_pk_fma_f16 v94, v20, v62, v94
    v_cvt_pk_f16_f32 v22, v174, v175
    v_cvt_pk_f16_f32 v23, v190, v191
    v_pk_fma_f16 v24, v71, s64, v22 neg_lo:[0,0,1] neg_hi:[0,0,1]
    v_pk_fma_f16 v25, v79, s64, v23 neg_lo:[0,0,1] neg_hi:[0,0,1]
    v_pk_mul_f16 v71, v22, v39
    v_pk_mul_f16 v79, v23, v39
    v_pk_mul_f16 v87, v24, v55
    v_pk_mul_f16 v95, v25, v55
    v_pk_fma_f16 v71, v23, v47, v71 neg_lo:[1,0,0] neg_hi:[1,0,0]
    v_pk_fma_f16 v79, v22, v47, v79
    v_pk_fma_f16 v87, v25, v63, v87 neg_lo:[1,0,0] neg_hi:[1,0,0]
    v_pk_fma_f16 v95, v24, v63, v95
    v_mfma_f32_32x32x16_f16 v[128:143], v[64:67], a[64:67], 0
    v_cvt_pk_f16_f32 v96, v192, v193
    v_cvt_pk_f16_f32 v104, v208, v209
    v_cvt_pk_f16_f32 v97, v194, v195
    v_cvt_pk_f16_f32 v105, v210, v211
    v_cvt_pk_f16_f32 v98, v196, v197
    v_cvt_pk_f16_f32 v106, v212, v213
    v_mfma_f32_32x32x16_f16 v[128:143], v[68:71], a[68:71], v[128:143]
    v_cvt_pk_f16_f32 v99, v198, v199
    v_cvt_pk_f16_f32 v107, v214, v215
    v_cvt_pk_f16_f32 v100, v200, v201
    v_cvt_pk_f16_f32 v108, v216, v217
    v_cvt_pk_f16_f32 v101, v202, v203
    v_cvt_pk_f16_f32 v109, v218, v219
    v_cvt_pk_f16_f32 v102, v204, v205
    v_mfma_f32_32x32x16_f16 v[128:143], v[72:75], a[80:83], v[128:143]
    v_cvt_pk_f16_f32 v110, v220, v221
    v_cvt_pk_f16_f32 v103, v206, v207
    v_cvt_pk_f16_f32 v111, v222, v223
    v_cvt_pk_f16_f32 v18, v224, v225
    v_cvt_pk_f16_f32 v19, v240, v241
    v_pk_fma_f16 v20, v96, s64, v18 neg_lo:[0,0,1] neg_hi:[0,0,1]
    v_pk_fma_f16 v21, v104, s64, v19 neg_lo:[0,0,1] neg_hi:[0,0,1]
    v_mfma_f32_32x32x16_f16 v[128:143], v[76:79], a[84:87], v[128:143]
    v_pk_mul_f16 v96, v18, v32
    v_pk_mul_f16 v104, v19, v32
    v_pk_mul_f16 v112, v20, v48
    v_pk_mul_f16 v120, v21, v48
    v_pk_fma_f16 v96, v19, v40, v96 neg_lo:[1,0,0] neg_hi:[1,0,0]
    v_pk_fma_f16 v104, v18, v40, v104
    v_pk_fma_f16 v112, v21, v56, v112 neg_lo:[1,0,0] neg_hi:[1,0,0]
    v_mfma_f32_32x32x16_f16 v[144:159], v[72:75], a[64:67], 0
    v_pk_fma_f16 v120, v20, v56, v120
    v_cvt_pk_f16_f32 v22, v226, v227
    v_cvt_pk_f16_f32 v23, v242, v243
    v_pk_fma_f16 v24, v97, s64, v22 neg_lo:[0,0,1] neg_hi:[0,0,1]
    v_pk_fma_f16 v25, v105, s64, v23 neg_lo:[0,0,1] neg_hi:[0,0,1]
    v_pk_mul_f16 v97, v22, v33
    v_pk_mul_f16 v105, v23, v33
    v_mfma_f32_32x32x16_f16 v[144:159], v[76:79], a[68:71], v[144:159]
    v_pk_mul_f16 v113, v24, v49
    v_pk_mul_f16 v121, v25, v49
    v_pk_fma_f16 v97, v23, v41, v97 neg_lo:[1,0,0] neg_hi:[1,0,0]
    v_pk_fma_f16 v105, v22, v41, v105
    v_pk_fma_f16 v113, v25, v57, v113 neg_lo:[1,0,0] neg_hi:[1,0,0]
    v_pk_fma_f16 v121, v24, v57, v121
    v_cvt_pk_f16_f32 v18, v228, v229
    v_mfma_f32_32x32x16_f16 v[144:159], v[64:67], a[72:75], v[144:159]
    v_cvt_pk_f16_f32 v19, v244, v245
    v_pk_fma_f16 v20, v98, s64, v18 neg_lo:[0,0,1] neg_hi:[0,0,1]
    v_pk_fma_f16 v21, v106, s64, v19 neg_lo:[0,0,1] neg_hi:[0,0,1]
    v_pk_mul_f16 v98, v18, v34
    v_pk_mul_f16 v106, v19, v34
    v_pk_mul_f16 v114, v20, v50
    v_pk_mul_f16 v122, v21, v50
    v_mfma_f32_32x32x16_f16 v[144:159], v[68:71], a[76:79], v[144:159]
    v_pk_fma_f16 v98, v19, v42, v98 neg_lo:[1,0,0] neg_hi:[1,0,0]
    v_pk_fma_f16 v106, v18, v42, v106
    v_pk_fma_f16 v114, v21, v58, v114 neg_lo:[1,0,0] neg_hi:[1,0,0]
    v_pk_fma_f16 v122, v20, v58, v122
    v_cvt_pk_f16_f32 v22, v230, v231
    v_cvt_pk_f16_f32 v23, v246, v247
    v_pk_fma_f16 v24, v99, s64, v22 neg_lo:[0,0,1] neg_hi:[0,0,1]
    v_mfma_f32_32x32x16_f16 v[160:175], v[80:83], a[64:67], 0
    v_pk_fma_f16 v25, v107, s64, v23 neg_lo:[0,0,1] neg_hi:[0,0,1]
    v_pk_mul_f16 v99, v22, v35
    v_pk_mul_f16 v107, v23, v35
    v_pk_mul_f16 v115, v24, v51
    v_pk_mul_f16 v123, v25, v51
    v_pk_fma_f16 v99, v23, v43, v99 neg_lo:[1,0,0] neg_hi:[1,0,0]
    v_pk_fma_f16 v107, v22, v43, v107
    v_mfma_f32_32x32x16_f16 v[160:175], v[84:87], a[68:71], v[160:175]
    v_pk_fma_f16 v115, v25, v59, v115 neg_lo:[1,0,0] neg_hi:[1,0,0]
    v_pk_fma_f16 v123, v24, v59, v123
    v_cvt_pk_f16_f32 v18, v232, v233
    v_cvt_pk_f16_f32 v19, v248, v249
    v_pk_fma_f16 v20, v100, s64, v18 neg_lo:[0,0,1] neg_hi:[0,0,1]
    v_pk_fma_f16 v21, v108, s64, v19 neg_lo:[0,0,1] neg_hi:[0,0,1]
    v_pk_mul_f16 v100, v18, v36
    v_mfma_f32_32x32x16_f16 v[160:175], v[88:91], a[80:83], v[160:175]
    v_pk_mul_f16 v108, v19, v36
    v_pk_mul_f16 v116, v20, v52
    v_pk_mul_f16 v124, v21, v52
    v_pk_fma_f16 v100, v19, v44, v100 neg_lo:[1,0,0] neg_hi:[1,0,0]
    v_pk_fma_f16 v108, v18, v44, v108
    v_pk_fma_f16 v116, v21, v60, v116 neg_lo:[1,0,0] neg_hi:[1,0,0]
    v_pk_fma_f16 v124, v20, v60, v124
    v_mfma_f32_32x32x16_f16 v[160:175], v[92:95], a[84:87], v[160:175]
    v_cvt_pk_f16_f32 v22, v234, v235
    v_cvt_pk_f16_f32 v23, v250, v251
    v_pk_fma_f16 v24, v101, s64, v22 neg_lo:[0,0,1] neg_hi:[0,0,1]
    v_pk_fma_f16 v25, v109, s64, v23 neg_lo:[0,0,1] neg_hi:[0,0,1]
    v_pk_mul_f16 v101, v22, v37
    v_pk_mul_f16 v109, v23, v37
    v_pk_mul_f16 v117, v24, v53
    v_mfma_f32_32x32x16_f16 v[176:191], v[88:91], a[64:67], 0
    v_pk_mul_f16 v125, v25, v53
    v_pk_fma_f16 v101, v23, v45, v101 neg_lo:[1,0,0] neg_hi:[1,0,0]
    v_pk_fma_f16 v109, v22, v45, v109
    v_pk_fma_f16 v117, v25, v61, v117 neg_lo:[1,0,0] neg_hi:[1,0,0]
    v_pk_fma_f16 v125, v24, v61, v125
    v_cvt_pk_f16_f32 v18, v236, v237
    v_cvt_pk_f16_f32 v19, v252, v253
    v_mfma_f32_32x32x16_f16 v[176:191], v[92:95], a[68:71], v[176:191]
    v_pk_fma_f16 v20, v102, s64, v18 neg_lo:[0,0,1] neg_hi:[0,0,1]
    v_pk_fma_f16 v21, v110, s64, v19 neg_lo:[0,0,1] neg_hi:[0,0,1]
    v_pk_mul_f16 v102, v18, v38
    v_pk_mul_f16 v110, v19, v38
    v_pk_mul_f16 v118, v20, v54
    v_pk_mul_f16 v126, v21, v54
    v_pk_fma_f16 v102, v19, v46, v102 neg_lo:[1,0,0] neg_hi:[1,0,0]
    v_mfma_f32_32x32x16_f16 v[176:191], v[80:83], a[72:75], v[176:191]
    v_pk_fma_f16 v110, v18, v46, v110
    v_pk_fma_f16 v118, v21, v62, v118 neg_lo:[1,0,0] neg_hi:[1,0,0]
    v_pk_fma_f16 v126, v20, v62, v126
    v_cvt_pk_f16_f32 v22, v238, v239
    v_cvt_pk_f16_f32 v23, v254, v255
    v_pk_fma_f16 v24, v103, s64, v22 neg_lo:[0,0,1] neg_hi:[0,0,1]
    v_pk_fma_f16 v25, v111, s64, v23 neg_lo:[0,0,1] neg_hi:[0,0,1]
    v_mfma_f32_32x32x16_f16 v[176:191], v[84:87], a[76:79], v[176:191]
    v_pk_mul_f16 v103, v22, v39
    v_pk_mul_f16 v111, v23, v39
    v_pk_mul_f16 v119, v24, v55
    v_pk_mul_f16 v127, v25, v55
    v_pk_fma_f16 v103, v23, v47, v103 neg_lo:[1,0,0] neg_hi:[1,0,0]
    v_pk_fma_f16 v111, v22, v47, v111
    v_pk_fma_f16 v119, v25, v63, v119 neg_lo:[1,0,0] neg_hi:[1,0,0]
    v_pk_fma_f16 v127, v24, v63, v127
    v_mfma_f32_32x32x16_f16 v[192:207], v[96:99], a[64:67], 0
    v_mul_f32 v128, v128, v11
    v_mul_f32 v144, v144, v11
    v_mul_f32 v129, v129, v11
    v_mul_f32 v145, v145, v11
    v_cvt_pk_bf16_f32 v32, v128, v144
    v_cvt_pk_bf16_f32 v34, v129, v145
    v_mfma_f32_32x32x16_f16 v[192:207], v[100:103], a[68:71], v[192:207]
    v_mul_f32 v130, v130, v11
    v_mul_f32 v146, v146, v11
    v_mul_f32 v131, v131, v11
    v_mul_f32 v147, v147, v11
    v_cvt_pk_bf16_f32 v36, v130, v146
    v_cvt_pk_bf16_f32 v38, v131, v147
    v_mfma_f32_32x32x16_f16 v[192:207], v[104:107], a[80:83], v[192:207]
    v_mul_f32 v132, v132, v11
    v_mul_f32 v148, v148, v11
    v_mul_f32 v133, v133, v11
    v_mul_f32 v149, v149, v11
    v_cvt_pk_bf16_f32 v40, v132, v148
    v_cvt_pk_bf16_f32 v42, v133, v149
    v_mfma_f32_32x32x16_f16 v[192:207], v[108:111], a[84:87], v[192:207]
    v_mul_f32 v134, v134, v11
    v_mul_f32 v150, v150, v11
    v_mul_f32 v135, v135, v11
    v_mul_f32 v151, v151, v11
    v_cvt_pk_bf16_f32 v44, v134, v150
    v_cvt_pk_bf16_f32 v46, v135, v151
    v_mfma_f32_32x32x16_f16 v[208:223], v[104:107], a[64:67], 0
    v_mul_f32 v136, v136, v11
    v_mul_f32 v152, v152, v11
    v_mul_f32 v137, v137, v11
    v_mul_f32 v153, v153, v11
    v_cvt_pk_bf16_f32 v48, v136, v152
    v_cvt_pk_bf16_f32 v50, v137, v153
    v_mfma_f32_32x32x16_f16 v[208:223], v[108:111], a[68:71], v[208:223]
    v_mul_f32 v138, v138, v11
    v_mul_f32 v154, v154, v11
    v_mul_f32 v139, v139, v11
    v_mul_f32 v155, v155, v11
    v_cvt_pk_bf16_f32 v52, v138, v154
    v_cvt_pk_bf16_f32 v54, v139, v155
    v_mfma_f32_32x32x16_f16 v[208:223], v[96:99], a[72:75], v[208:223]
    v_mul_f32 v140, v140, v11
    v_mul_f32 v156, v156, v11
    v_mul_f32 v141, v141, v11
    v_mul_f32 v157, v157, v11
    v_cvt_pk_bf16_f32 v56, v140, v156
    v_cvt_pk_bf16_f32 v58, v141, v157
    v_mfma_f32_32x32x16_f16 v[208:223], v[100:103], a[76:79], v[208:223]
    v_mul_f32 v142, v142, v11
    v_mul_f32 v158, v158, v11
    v_mul_f32 v143, v143, v11
    v_mul_f32 v159, v159, v11
    v_cvt_pk_bf16_f32 v60, v142, v158
    v_cvt_pk_bf16_f32 v62, v143, v159
    v_mfma_f32_32x32x16_f16 v[224:239], v[112:115], a[64:67], 0
    v_mfma_f32_32x32x16_f16 v[224:239], v[116:119], a[68:71], v[224:239]
    v_mul_f32 v192, v192, v12
    s_nop 2
    v_mul_f32 v208, v208, v12
    v_mul_f32 v193, v193, v12
    v_mul_f32 v209, v209, v12
    v_cvt_pk_bf16_f32 v33, v192, v208
    v_cvt_pk_bf16_f32 v35, v193, v209
    v_mfma_f32_32x32x16_f16 v[224:239], v[120:123], a[80:83], v[224:239]
    buffer_store_dwordx4 v[32:35], v10, s[36:39], s4 offen sc1
    v_mfma_f32_32x32x16_f16 v[224:239], v[124:127], a[84:87], v[224:239]
    v_mul_f32 v194, v194, v12
    v_mul_f32 v210, v210, v12
    v_mul_f32 v195, v195, v12
    v_mul_f32 v211, v211, v12
    v_cvt_pk_bf16_f32 v37, v194, v210
    v_cvt_pk_bf16_f32 v39, v195, v211
    v_mfma_f32_32x32x16_f16 v[240:255], v[120:123], a[64:67], 0
    buffer_store_dwordx4 v[36:39], v10, s[36:39], s5 offen sc1
    v_mfma_f32_32x32x16_f16 v[240:255], v[124:127], a[68:71], v[240:255]
    v_mul_f32 v196, v196, v12
    v_mul_f32 v212, v212, v12
    v_mul_f32 v197, v197, v12
    v_mul_f32 v213, v213, v12
    v_cvt_pk_bf16_f32 v41, v196, v212
    v_cvt_pk_bf16_f32 v43, v197, v213
    v_mfma_f32_32x32x16_f16 v[240:255], v[112:115], a[72:75], v[240:255]
    buffer_store_dwordx4 v[40:43], v10, s[36:39], s6 offen sc1
    v_mfma_f32_32x32x16_f16 v[240:255], v[116:119], a[76:79], v[240:255]
    v_mul_f32 v198, v198, v12
    v_mul_f32 v214, v214, v12
    v_mul_f32 v199, v199, v12
    v_mul_f32 v215, v215, v12
    v_cvt_pk_bf16_f32 v45, v198, v214
    v_cvt_pk_bf16_f32 v47, v199, v215
    buffer_store_dwordx4 v[44:47], v10, s[36:39], s7 offen sc1
    v_mul_f32 v200, v200, v12
    v_mul_f32 v216, v216, v12
    v_mul_f32 v201, v201, v12
    v_mul_f32 v217, v217, v12
    v_cvt_pk_bf16_f32 v49, v200, v216
    v_cvt_pk_bf16_f32 v51, v201, v217
    buffer_store_dwordx4 v[48:51], v10, s[36:39], s8 offen sc1
    v_mul_f32 v202, v202, v12
    v_mul_f32 v218, v218, v12
    v_mul_f32 v203, v203, v12
    v_mul_f32 v219, v219, v12
    v_cvt_pk_bf16_f32 v53, v202, v218
    v_cvt_pk_bf16_f32 v55, v203, v219
    buffer_store_dwordx4 v[52:55], v10, s[36:39], s9 offen sc1
    v_mul_f32 v204, v204, v12
    v_mul_f32 v220, v220, v12
    v_mul_f32 v205, v205, v12
    v_mul_f32 v221, v221, v12
    v_cvt_pk_bf16_f32 v57, v204, v220
    v_cvt_pk_bf16_f32 v59, v205, v221
    buffer_store_dwordx4 v[56:59], v10, s[36:39], s10 offen sc1
    v_mul_f32 v206, v206, v12
    v_mul_f32 v222, v222, v12
    v_mul_f32 v207, v207, v12
    v_mul_f32 v223, v223, v12
    v_cvt_pk_bf16_f32 v61, v206, v222
    v_cvt_pk_bf16_f32 v63, v207, v223
    buffer_store_dwordx4 v[60:63], v10, s[36:39], s11 offen sc1
    v_pk_mul_f32 v[160:161], v[160:161], v[10:11] op_sel:[0,1]
    v_pk_mul_f32 v[176:177], v[176:177], v[10:11] op_sel:[0,1]
    v_cvt_pk_bf16_f32 v64, v160, v176
    v_cvt_pk_bf16_f32 v66, v161, v177
    v_pk_mul_f32 v[162:163], v[162:163], v[10:11] op_sel:[0,1]
    v_pk_mul_f32 v[178:179], v[178:179], v[10:11] op_sel:[0,1]
    v_cvt_pk_bf16_f32 v68, v162, v178
    v_cvt_pk_bf16_f32 v70, v163, v179
    v_pk_mul_f32 v[164:165], v[164:165], v[10:11] op_sel:[0,1]
    v_pk_mul_f32 v[180:181], v[180:181], v[10:11] op_sel:[0,1]
    v_cvt_pk_bf16_f32 v72, v164, v180
    v_cvt_pk_bf16_f32 v74, v165, v181
    v_pk_mul_f32 v[166:167], v[166:167], v[10:11] op_sel:[0,1]
    v_pk_mul_f32 v[182:183], v[182:183], v[10:11] op_sel:[0,1]
    v_cvt_pk_bf16_f32 v76, v166, v182
    v_cvt_pk_bf16_f32 v78, v167, v183
    v_pk_mul_f32 v[168:169], v[168:169], v[10:11] op_sel:[0,1]
    v_pk_mul_f32 v[184:185], v[184:185], v[10:11] op_sel:[0,1]
    v_cvt_pk_bf16_f32 v80, v168, v184
    v_cvt_pk_bf16_f32 v82, v169, v185
    v_pk_mul_f32 v[170:171], v[170:171], v[10:11] op_sel:[0,1]
    v_pk_mul_f32 v[186:187], v[186:187], v[10:11] op_sel:[0,1]
    v_cvt_pk_bf16_f32 v84, v170, v186
    v_cvt_pk_bf16_f32 v86, v171, v187
    v_pk_mul_f32 v[172:173], v[172:173], v[10:11] op_sel:[0,1]
    v_pk_mul_f32 v[188:189], v[188:189], v[10:11] op_sel:[0,1]
    v_cvt_pk_bf16_f32 v88, v172, v188
    v_cvt_pk_bf16_f32 v90, v173, v189
    v_pk_mul_f32 v[174:175], v[174:175], v[10:11] op_sel:[0,1]
    v_pk_mul_f32 v[190:191], v[190:191], v[10:11] op_sel:[0,1]
    v_cvt_pk_bf16_f32 v92, v174, v190
    v_cvt_pk_bf16_f32 v94, v175, v191
    v_pk_mul_f32 v[224:225], v[224:225], v[12:13] op_sel_hi:[1,0]
    v_pk_mul_f32 v[240:241], v[240:241], v[12:13] op_sel_hi:[1,0]
    v_cvt_pk_bf16_f32 v65, v224, v240
    v_cvt_pk_bf16_f32 v67, v225, v241
    v_pk_mul_f32 v[226:227], v[226:227], v[12:13] op_sel_hi:[1,0]
    v_pk_mul_f32 v[242:243], v[242:243], v[12:13] op_sel_hi:[1,0]
    v_cvt_pk_bf16_f32 v69, v226, v242
    v_cvt_pk_bf16_f32 v71, v227, v243
    buffer_store_dwordx4 v[64:67], v10, s[36:39], s12 offen sc1
    buffer_store_dwordx4 v[68:71], v10, s[36:39], s13 offen sc1
    v_pk_mul_f32 v[228:229], v[228:229], v[12:13] op_sel_hi:[1,0]
    v_pk_mul_f32 v[244:245], v[244:245], v[12:13] op_sel_hi:[1,0]
    v_cvt_pk_bf16_f32 v73, v228, v244
    v_cvt_pk_bf16_f32 v75, v229, v245
    v_pk_mul_f32 v[230:231], v[230:231], v[12:13] op_sel_hi:[1,0]
    v_pk_mul_f32 v[246:247], v[246:247], v[12:13] op_sel_hi:[1,0]
    v_cvt_pk_bf16_f32 v77, v230, v246
    v_cvt_pk_bf16_f32 v79, v231, v247
    buffer_store_dwordx4 v[72:75], v10, s[36:39], s14 offen sc1
    buffer_store_dwordx4 v[76:79], v10, s[36:39], s15 offen sc1
    v_pk_mul_f32 v[232:233], v[232:233], v[12:13] op_sel_hi:[1,0]
    v_pk_mul_f32 v[248:249], v[248:249], v[12:13] op_sel_hi:[1,0]
    v_cvt_pk_bf16_f32 v81, v232, v248
    v_cvt_pk_bf16_f32 v83, v233, v249
    v_pk_mul_f32 v[234:235], v[234:235], v[12:13] op_sel_hi:[1,0]
    v_pk_mul_f32 v[250:251], v[250:251], v[12:13] op_sel_hi:[1,0]
    v_cvt_pk_bf16_f32 v85, v234, v250
    v_cvt_pk_bf16_f32 v87, v235, v251
    buffer_store_dwordx4 v[80:83], v10, s[36:39], s16 offen sc1
    buffer_store_dwordx4 v[84:87], v10, s[36:39], s17 offen sc1
    v_pk_mul_f32 v[236:237], v[236:237], v[12:13] op_sel_hi:[1,0]
    v_pk_mul_f32 v[252:253], v[252:253], v[12:13] op_sel_hi:[1,0]
    v_cvt_pk_bf16_f32 v89, v236, v252
    v_cvt_pk_bf16_f32 v91, v237, v253
    v_pk_mul_f32 v[238:239], v[238:239], v[12:13] op_sel_hi:[1,0]
    v_pk_mul_f32 v[254:255], v[254:255], v[12:13] op_sel_hi:[1,0]
    v_cvt_pk_bf16_f32 v93, v238, v254
    v_cvt_pk_bf16_f32 v95, v239, v255
    buffer_store_dwordx4 v[88:91], v10, s[36:39], s18 offen sc1
    buffer_store_dwordx4 v[92:95], v10, s[36:39], s19 offen sc1
    s_mul_i32 s54, s45, 37
    s_lshr_b32 s54, s54, 8
    s_mul_i32 s54, s54, 25
    s_add_u32 s54, s54, s45
    s_mul_i32 s48, s44, 7
    s_add_u32 s48, s48, s54
    s_lshl2_add_u32 s48, s48, 65536
    v_add_u32 v7, 32, v0
    v_and_b32 v7, 64, v7
    v_lshlrev_b32 v6, 9, v0
    v_lshl_add_u32 v6, v7, 24, v6
    s_waitcnt vmcnt(0)
    buffer_atomic_swap v5, v6, s[36:39], s48 offen offset:0 sc1
L_end:
    s_endpgm
L_pl6:
    s_mov_b32 s63, 0
L_pr6:
    s_sleep 1
    v_mov_b32 v16, 0
    buffer_atomic_or v16, v15, s[36:39], s47 offen offset:0 sc0 sc1
    s_add_u32 s63, s63, 1
    s_cmp_gt_u32 s63, 400000
    s_waitcnt vmcnt(0)
    s_cbranch_scc1 L_pd6
    v_cmp_ne_u32 vcc, v5, v16
    s_nop 1
    s_and_b32 vcc_lo, vcc_lo, 0xffff
    s_cbranch_scc1 L_pr6
    s_branch L_pd6
L_pl7:
    s_mov_b32 s63, 0
L_pr7:
    s_sleep 1
    v_mov_b32 v8, 0
    v_mov_b32 v9, 0
    buffer_atomic_or_x2 v[8:9], v7, s[36:39], s46 offen offset:0 sc0 sc1
    s_add_u32 s63, s63, 1
    s_cmp_gt_u32 s63, 400000
    s_waitcnt vmcnt(0)
    s_cbranch_scc1 L_pd7
    v_cmp_ne_u32 vcc, v5, v8
    s_nop 1
    s_and_b32 vcc_lo, vcc_lo, 0xffffffff
    s_cbranch_scc1 L_pr7
    s_branch L_pd7
L_codeend:
    .fill 512, 4, 0xbf810000
.section .rodata,"a"
.p2align 6
.amdhsa_kernel parallel_sum__spectral_gfnet__glu_gated_swiglu__prompt_kernel
  .amdhsa_next_free_vgpr 512
  .amdhsa_next_free_sgpr 102
  .amdhsa_accum_offset 256
  .amdhsa_group_segment_fixed_size 0
  .amdhsa_kernarg_size 80
  .amdhsa_user_sgpr_count 2
  .amdhsa_user_sgpr_kernarg_segment_ptr 1
  .amdhsa_system_sgpr_workgroup_id_x 1
  .amdhsa_float_denorm_mode_32 3
.end_amdhsa_kernel
```
